```python
import torch

def _softmax(x, axis=-1):
    return torch.softmax(x, dim=axis)

def _gelu(x):
    return torch.nn.functional.gelu(x, approximate='tanh')

def _silu(x):
    return torch.nn.functional.silu(x)

def _sigmoid(x):
    return torch.sigmoid(x)

def _layernorm(x, axis=-1, eps=1e-05):
    m = x.mean(dim=axis, keepdim=True)
    v = x.var(dim=axis, keepdim=True, unbiased=False)
    return (x - m) / torch.sqrt(v + eps)

def _scatter_add(tgt, idx, src, axis=0):
    return tgt.clone().index_add_(axis, idx, src)

def _segment_sum(src, seg, n):
    out = torch.zeros((n,) + src.shape[1:], dtype=src.dtype)
    return out.index_add_(0, seg, src)

def _pad(x, pw):
    flat = tuple((v for pair in reversed(pw) for v in pair))
    return torch.nn.functional.pad(x, flat)
kernel_name = 'adaLN_cond__compressed_kv_cla__dense_activation_relu__decode'

def setup_inputs():

    _w = lambda a: (lambda t: t.to(torch.bfloat16) if t.is_floating_point() else t)(torch.as_tensor(a))

    def _A_setup():
        B, H, Sq, Sk, D, M = (2, 32, 1, 8192, 128, 512)
        Dc = 4 * D
        return {'x': _w((lambda *s: torch.randn(*s, dtype=torch.bfloat16) * 0.05)(B, Sq, M)), 'c_kv': _w((lambda *s: torch.randn(*s, dtype=torch.bfloat16) * 1.6)(B, Sk, Dc)), 'w_q': _w((lambda *s: torch.randn(*s, dtype=torch.bfloat16) * 1.6)(M, H, D) * M ** (-0.5)), 'w_uk': _w((lambda *s: torch.randn(*s, dtype=torch.bfloat16) * 1.6)(Dc, H, D) * Dc ** (-0.5)), 'w_uv': _w((lambda *s: torch.randn(*s, dtype=torch.bfloat16) * 1.6)(Dc, H, D) * Dc ** (-0.5)), 'w_o': _w((lambda *s: torch.randn(*s, dtype=torch.bfloat16) * 1.6)(H, D, M) * (H * D) ** (-0.5))}
    _A_in = _A_setup()

    def _B_setup():
        B, S, D, Dff = (2, 1, 512, 1792)
        return {'x': _w((lambda *s: torch.randn(*s, dtype=torch.bfloat16) * 0.05)(B, S, D)), 'w1': _w((lambda *s: torch.randn(*s, dtype=torch.bfloat16) * 0.05)(D, Dff)), 'w2': _w((lambda *s: torch.randn(*s, dtype=torch.bfloat16) * 0.05)(Dff, D))}
    _B_in = _B_setup()
    return {'A_x': _A_in['x'], 'A_c_kv': _A_in['c_kv'], 'A_w_q': _A_in['w_q'], 'A_w_uk': _A_in['w_uk'], 'A_w_uv': _A_in['w_uv'], 'A_w_o': _A_in['w_o'], 'B_x': _B_in['x'], 'B_w1': _B_in['w1'], 'B_w2': _B_in['w2'], 'c': _w((lambda *s: torch.randn(*s, dtype=torch.bfloat16) * 0.2)(2, 512) * 8.0), 'w_mod': _w((lambda *s: torch.randn(*s, dtype=torch.bfloat16) * 0.2)(512, 6 * 512) * 512 ** (-0.5) * 8.0)}

def reference(A_x, A_c_kv, A_w_q, A_w_uk, A_w_uv, A_w_o, B_x, B_w1, B_w2, c, w_mod):

    def _A_ref(x, c_kv, w_q, w_uk, w_uv, w_o):
        B, Sq, M = (x.shape[0], x.shape[1], x.shape[2])
        Sk = c_kv.shape[1]
        H, D = (w_q.shape[1], w_q.shape[2])
        q = torch.einsum('bqm,mhd->bhqd', x, w_q)
        k = torch.einsum('bkc,chd->bhkd', c_kv, w_uk)
        v = torch.einsum('bkc,chd->bhkd', c_kv, w_uv)
        scores = torch.einsum('bhqd,bhkd->bhqk', q, k) * D ** (-0.5)
        off = Sk - Sq
        qi = torch.arange(Sq)[:, None]
        kj = torch.arange(Sk)[None, :]
        cmask = kj <= qi + off
        scores = torch.where(cmask[None, None], scores, -1000000000.0)
        p = _softmax(scores, axis=-1)
        ctx = torch.einsum('bhqk,bhkd->bhqd', p, v)
        return torch.einsum('bhqd,hdm->bqm', ctx, w_o)

    def _B_ref(x, w1, w2):
        h = torch.einsum('bsd,df->bsf', x, w1)
        zero = torch.zeros_like(h)
        h = torch.maximum(h, zero)
        return torch.einsum('bsf,fd->bsd', h, w2)
    x = A_x
    mod = (_silu(c) @ w_mod).reshape(c.shape[0], 6, 1, -1)
    sa, ca, ga, sb, cb, gb = (mod[:, 0].clone(), mod[:, 1].clone(), mod[:, 2].clone(), mod[:, 3].clone(), mod[:, 4].clone(), mod[:, 5].clone())
    h = _layernorm(x, axis=-1) * (1 + ca) + sa
    x = x + ga * _A_ref(h, A_c_kv, A_w_q, A_w_uk, A_w_uv, A_w_o)
    h = _layernorm(x, axis=-1) * (1 + cb) + sb
    x = x + gb * _B_ref(h, B_w1, B_w2)
    return x
```

```asm
; @launch grid=(256,1,1) block=(256,1,1) lds=163840
.amdgcn_target "amdgcn-amd-amdhsa--gfx950"
.text
.globl adaLN_cond__compressed_kv_cla__dense_activation_relu__decode_kernel
.p2align 8
.type adaLN_cond__compressed_kv_cla__dense_activation_relu__decode_kernel,@function
adaLN_cond__compressed_kv_cla__dense_activation_relu__decode_kernel:
    s_cmp_lt_u32 s2, 0x100
    s_cbranch_scc1 Lrun
    s_endpgm
Lrun:
    s_load_dwordx2 s[12:13], s[0:1], 72
    s_load_dwordx2 s[8:9], s[0:1], 0
    s_load_dwordx2 s[16:17], s[0:1], 80
    s_load_dwordx2 s[4:5], s[0:1], 104
    v_lshrrev_b32 v1, 6, v0
    s_bfe_u32 s43, s2, 0x40003
    v_readfirstlane_b32 s41, v1
    s_mov_b32 s14, 2048
    s_mov_b32 s15, 0x20000
    s_mov_b32 s10, 2048
    s_mov_b32 s11, 0x20000
    s_mov_b32 s18, 3145728
    s_mov_b32 s19, 0x20000
    s_mov_b32 s6, 5242880
    s_mov_b32 s7, 0x20000
    s_lshl_b32 s3, s41, 8
    s_or_b32 s42, s3, s2
    s_bitcmp0_b32 s2, 7
    s_cbranch_scc1 Lrole_a
    s_load_dwordx2 s[20:21], s[0:1], 16
    s_load_dwordx2 s[24:25], s[0:1], 24
    s_load_dwordx2 s[28:29], s[0:1], 32
    s_load_dwordx2 s[36:37], s[0:1], 88
    s_mov_b32 s22, 4194304
    s_mov_b32 s23, 0x20000
    s_mov_b32 s26, 4194304
    s_mov_b32 s27, 0x20000
    s_mov_b32 s30, 4194304
    s_mov_b32 s31, 0x20000
    s_mov_b32 s38, 2048
    s_mov_b32 s39, 0x20000
    v_bfe_u32 v31, v0, 4, 2
    v_lshlrev_b32 v30, 2, v31
    v_bfe_u32 v32, v0, 6, 2
    v_lshl_add_u32 v30, v32, 0, v30
    v_bfe_u32 v33, v0, 0, 4
    v_xor_b32 v30, v30, v33
    v_lshlrev_b32 v34, 4, v30
    v_lshl_add_u32 v34, v31, 13, v34
    v_add_u32 v35, 31744, v34
    s_bfe_u32 s3, s42, 0x20003
    s_lshl_b32 s45, s3, 20
    s_bfe_u32 s3, s42, 0x30000
    s_lshl_b32 s3, s3, 10
    s_add_u32 s45, s3, s45
    s_bfe_u32 s3, s42, 0x20005
    s_lshl_b32 s3, s3, 8
    s_add_u32 s45, s3, s45
    s_bfe_u32 s3, s42, 0x20008
    s_lshl_b32 s3, s3, 16
    s_add_u32 s45, s3, s45
    s_mov_b32 s46, s45
    s_waitcnt lgkmcnt(0)
    s_load_dword s40, s[4:5], 0
    s_bfe_u32 s3, s42, 0x20008
    s_lshl_b32 m0, s3, 11
    s_nop 0
    buffer_load_dwordx4 v34, s[20:23], s45 offen nt lds
    buffer_load_dwordx4 v35, s[20:23], s45 offen offset:1024 nt lds
    s_add_u32 m0, m0, 8192
    s_add_u32 s45, s45, 262144
    buffer_load_dwordx4 v34, s[20:23], s45 offen nt lds
    buffer_load_dwordx4 v35, s[20:23], s45 offen offset:1024 nt lds
    s_add_u32 m0, m0, 8192
    s_add_u32 s45, s45, 262144
    buffer_load_dwordx4 v34, s[20:23], s45 offen nt lds
    buffer_load_dwordx4 v35, s[20:23], s45 offen offset:1024 nt lds
    s_add_u32 m0, m0, 8192
    s_add_u32 s45, s45, 262144
    buffer_load_dwordx4 v34, s[20:23], s45 offen nt lds
    buffer_load_dwordx4 v35, s[20:23], s45 offen offset:1024 nt lds
    v_bfe_u32 v37, v0, 0, 6
    v_lshlrev_b32 v36, 4, v37
    s_bfe_u32 s3, s42, 0x30000
    s_lshl_b32 s3, s3, 13
    s_add_u32 s48, s3, 327680
    s_bfe_u32 s3, s42, 0x20005
    s_lshl_b32 s3, s3, 11
    s_add_u32 s48, s3, s48
    s_bfe_u32 s3, s42, 0x10009
    s_lshl_b32 s3, s3, 10
    s_add_u32 s48, s3, s48
    s_bfe_u32 s3, s42, 0x20003
    s_lshl_b32 s3, s3, 8
    s_add_u32 s48, s3, s48
    s_bfe_u32 s3, s42, 0x10008
    s_lshl_b32 s3, s3, 7
    s_add_u32 s48, s3, s48
    s_bfe_u32 s3, s42, 0x30000
    s_lshl_b32 s3, s3, 10
    s_add_u32 s50, s3, 40960
    s_bfe_u32 s3, s42, 0x30003
    s_lshl_b32 s3, s3, 7
    s_add_u32 s50, s3, s50
    s_bfe_u32 s3, s42, 0x30000
    s_lshl_b32 s3, s3, 14
    s_add_u32 s51, s3, 131072
    s_bfe_u32 s3, s42, 0x20005
    s_lshl_b32 s3, s3, 12
    s_add_u32 s51, s3, s51
    s_bfe_u32 s3, s42, 0x20008
    s_lshl_b32 s3, s3, 10
    s_add_u32 s51, s3, s51
    s_bfe_u32 s3, s42, 0x70000
    s_lshl_b32 s3, s3, 7
    s_add_u32 s45, s3, 49152
    v_mov_b64 v[18:19], -1
    v_mov_b64 v[20:21], -1
    s_add_u32 s49, s48, 327680
    s_cmp_ge_u32 s43, 8
    s_cselect_b32 s50, s50, 2146435072
    s_cmp_eq_u32 s41, 1
    s_cselect_b32 s3, s50, 2146435072
    s_cmp_eq_u32 s41, 0
    s_cselect_b32 s45, s45, s3
    s_mov_b64 exec, 0xff
    buffer_store_dwordx4 v[18:21], v36, s[4:7], s48 offen sc1
    buffer_store_dwordx4 v[18:21], v36, s[4:7], s49 offen sc1
    buffer_store_dwordx4 v[18:21], v36, s[4:7], s45 offen sc1
    s_mov_b64 exec, -1
    buffer_load_dwordx4 v[22:25], v36, s[4:7], s51 offen sc1
    s_bfe_u32 s3, s42, 0x20008
    s_lshl_b32 s3, s3, 11
    s_add_u32 m0, s3, 32768
    s_nop 0
    buffer_load_dwordx4 v34, s[24:27], s46 offen nt lds
    buffer_load_dwordx4 v35, s[24:27], s46 offen offset:1024 nt lds
    s_add_u32 m0, m0, 8192
    s_add_u32 s46, s46, 262144
    buffer_load_dwordx4 v34, s[24:27], s46 offen nt lds
    buffer_load_dwordx4 v35, s[24:27], s46 offen offset:1024 nt lds
    s_add_u32 m0, m0, 8192
    s_add_u32 s46, s46, 262144
    buffer_load_dwordx4 v34, s[24:27], s46 offen nt lds
    buffer_load_dwordx4 v35, s[24:27], s46 offen offset:1024 nt lds
    s_add_u32 m0, m0, 8192
    s_add_u32 s46, s46, 262144
    buffer_load_dwordx4 v34, s[24:27], s46 offen nt lds
    buffer_load_dwordx4 v35, s[24:27], s46 offen offset:1024 nt lds
    s_bfe_u32 s3, s42, 0x20003
    s_lshl_b32 s3, s3, 13
    s_add_u32 s52, s3, 8192
    s_bfe_u32 s3, s42, 0x20008
    s_lshl_b32 s3, s3, 11
    s_add_u32 s52, s3, s52
    v_lshlrev_b32 v38, 2, v32
    v_bfe_u32 v39, v0, 0, 2
    v_lshl_add_u32 v38, v39, 0, v38
    v_bfe_u32 v41, v0, 2, 2
    v_lshlrev_b32 v40, 2, v41
    v_lshl_add_u32 v40, v31, 0, v40
    v_xor_b32 v38, v38, v40
    v_lshlrev_b32 v42, 11, v31
    v_lshl_add_u32 v42, v41, 8, v42
    v_lshl_add_u32 v42, v38, 4, v42
    v_lshlrev_b32 v38, 2, v39
    v_lshl_add_u32 v38, v41, 0, v38
    v_xor_b32 v38, v38, v31
    s_mov_b32 s3, 32768
    v_bfe_u32 v48, v0, 6, 1
    v_lshl_add_u32 v44, v48, 14, s3
    v_lshl_add_u32 v44, v41, 11, v44
    v_lshl_add_u32 v44, v39, 8, v44
    v_lshl_add_u32 v44, v38, 4, v44
    v_xor_b32 v45, 64, v44
    v_xor_b32 v46, 128, v44
    v_xor_b32 v47, 192, v44
    s_mov_b32 s3, 133376
    v_lshl_add_u32 v49, v32, 6, s3
    v_bfe_u32 v50, v0, 1, 3
    v_lshl_add_u32 v49, v50, 3, v49
    v_bfe_u32 v51, v0, 0, 1
    s_mov_b32 s3, 288
    v_mad_u32_u24 v49, v51, s3, v49
    s_mov_b32 s3, 133376
    v_lshl_add_u32 v52, v31, 4, s3
    s_mov_b32 s3, 288
    v_mad_u32_u24 v52, v51, s3, v52
    v_lshlrev_b32 v53, 6, v31
    v_lshl_add_u32 v53, v39, 4, v53
    s_bfe_u32 s3, s42, 0x20003
    s_lshl_b32 s3, s3, 8
    s_add_u32 s53, s3, s51
    s_add_u32 s54, s53, 393216
    s_add_u32 s55, s51, 393216
    v_lshlrev_b32 v38, 3, v48
    v_bfe_u32 v54, v0, 1, 1
    v_lshl_add_u32 v38, v54, 2, v38
    v_lshl_add_u32 v38, v31, 0, v38
    s_bfe_u32 s3, s42, 0x10000
    s_lshl_b32 s56, s3, 3
    s_bfe_u32 s3, s42, 0x20005
    s_lshl_b32 s3, s3, 1
    s_add_u32 s56, s3, s56
    s_bfe_u32 s3, s42, 0x10001
    s_lshl_b32 s3, s3, 0
    s_add_u32 s56, s3, s56
    v_xor_b32 v38, s56, v38
    v_lshlrev_b32 v55, 15, v51
    v_lshl_add_u32 v55, v38, 4, v55
    s_bfe_u32 s3, s42, 0x20003
    s_lshl_b32 s3, s3, 13
    s_add_u32 s56, s3, 65536
    s_bfe_u32 s3, s42, 0x30000
    s_lshl_b32 s3, s3, 10
    s_add_u32 s56, s3, s56
    s_bfe_u32 s3, s42, 0x20005
    s_lshl_b32 s3, s3, 8
    s_add_u32 s56, s3, s56
    s_bfe_u32 s3, s42, 0x30000
    s_lshl_b32 s3, s3, 7
    s_add_u32 s57, s3, 4096
    s_bfe_u32 s3, s42, 0x20003
    s_lshl_b32 s3, s3, 2
    s_add_u32 s57, s3, s57
    s_and_b32 s3, s42, 0x360
    s_cmp_eq_u32 s3, 0x300
    s_cselect_b32 s57, s57, 2146435072
    v_lshlrev_b32 v58, 4, v51
    s_mov_b32 s3, 0x3f80
    v_lshlrev_b32 v58, v58, s3
    v_cmp_eq_u32 vcc, 0, v54
    s_nop 1
    v_cndmask_b32 v56, 0, v58, vcc
    v_cmp_eq_u32 vcc, 1, v54
    s_nop 1
    v_cndmask_b32 v57, 0, v58, vcc
    s_mov_b32 s34, 0xcccccccc
    s_mov_b32 s35, 0xcccccccc
    s_waitcnt lgkmcnt(0)
    s_add_u32 s40, s40, 0x9e3779b9
    v_mov_b32 v62, s40
    v_mov_b32 v63, s40
    s_mov_b64 exec, 0
    s_cmp_eq_u32 s41, 0
    s_cbranch_scc1 Lw_t1_0
    s_cmp_eq_u32 s41, 1
    s_cbranch_scc1 Lw_t1_1
    s_cmp_eq_u32 s41, 2
    s_cbranch_scc1 Lw_t1_2
    s_cmp_eq_u32 s41, 3
    s_cbranch_scc1 Lw_t1_3
Lw_t1_r:
    s_mov_b64 exec, -1
    v_lshlrev_b32 v34, 4, v30
    v_bfe_u32 v208, v0, 5, 1
    v_lshl_add_u32 v34, v208, 20, v34
    v_bfe_u32 v209, v0, 4, 1
    v_lshl_add_u32 v34, v209, 17, v34
    v_add_u32 v35, 2096128, v34
    s_bfe_u32 s3, s42, 0x20003
    s_lshl_b32 s45, s3, 18
    s_bfe_u32 s3, s42, 0x20008
    s_lshl_b32 s3, s3, 13
    s_add_u32 s45, s3, s45
    s_bfe_u32 s3, s42, 0x30000
    s_lshl_b32 s3, s3, 10
    s_add_u32 s45, s3, s45
    s_bfe_u32 s3, s42, 0x20005
    s_lshl_b32 s3, s3, 8
    s_add_u32 s45, s3, s45
    v_lshlrev_b32 v38, 1, v208
    v_xor_b32 v38, v38, v39
    v_lshlrev_b32 v3, 4, v38
    v_bfe_u32 v210, v0, 2, 4
    s_mov_b32 s3, 6144
Lw_t1_0:
    s_cbranch_execz Lw_t1_4
    v_mad_u32_u24 v3, v210, s3, v3
    v_bfe_u32 v211, v0, 0, 8
    v_lshlrev_b32 v2, 3, v211
    s_mov_b32 s3, 131072
    v_lshl_add_u32 v212, v2, 0, s3
    v_bfe_u32 v213, v0, 7, 1
    v_lshl_add_u32 v212, v213, 5, v212
    s_bfe_u32 s3, s42, 0x20008
    s_lshl_b32 s62, s3, 13
    s_load_dwordx2 s[20:21], s[0:1], 40
    s_load_dwordx2 s[24:25], s[0:1], 40
    s_mov_b32 s22, 4194304
    s_mov_b32 s23, 0x20000
    s_mov_b32 s26, 4194304
    s_mov_b32 s27, 0x20000
    v_lshlrev_b32 v38, 1, v31
    v_bfe_u32 v214, v0, 0, 3
Lw_t1_1:
    s_cbranch_execz Lw_t1_5
    v_xor_b32 v38, v38, v214
    v_bfe_u32 v215, v0, 3, 3
    v_lshlrev_b32 v4, 10, v215
    v_lshl_add_u32 v4, v38, 4, v4
    s_bfe_u32 s3, s42, 0x30000
    s_lshl_b32 s58, s3, 19
    s_bfe_u32 s3, s42, 0x20008
    s_lshl_b32 s3, s3, 16
    s_add_u32 s58, s3, s58
    s_bfe_u32 s3, s42, 0x30003
    s_lshl_b32 s3, s3, 7
    s_add_u32 s58, s3, s58
    v_mov_b32 v5, v4
    s_add_u32 s59, s58, 262144
    s_movk_i32 s60, 8192
    s_movk_i32 s61, 8192
    s_mov_b32 s44, 39999
    buffer_load_dwordx4 v[22:25], v36, s[4:7], s52 offen offset:0 sc1
    buffer_load_dwordx4 v[26:29], v36, s[4:7], s52 offen offset:1024 sc1
Lw_t1_2:
    s_cbranch_execz Lw_t1_6
    s_waitcnt vmcnt(14)
    s_barrier
    ds_read_b64_tr_b16 v[96:97], v42 offset:0
    ds_read_b64_tr_b16 v[98:99], v42 offset:1024
    ds_read_b64_tr_b16 v[112:113], v42 offset:8
    ds_read_b64_tr_b16 v[114:115], v42 offset:1032
    ds_read_b64_tr_b16 v[100:101], v42 offset:8192
    ds_read_b64_tr_b16 v[102:103], v42 offset:9216
    ds_read_b64_tr_b16 v[116:117], v42 offset:8200
    ds_read_b64_tr_b16 v[118:119], v42 offset:9224
    ds_read_b64_tr_b16 v[104:105], v42 offset:16384
    ds_read_b64_tr_b16 v[106:107], v42 offset:17408
    ds_read_b64_tr_b16 v[120:121], v42 offset:16392
    ds_read_b64_tr_b16 v[122:123], v42 offset:17416
    ds_read_b64_tr_b16 v[108:109], v42 offset:24576
    ds_read_b64_tr_b16 v[110:111], v42 offset:25600
    ds_read_b64_tr_b16 v[124:125], v42 offset:24584
Lw_t1_3:
    s_cbranch_execz Lw_t1_7
    s_waitcnt lgkmcnt(7)
    ds_read_b64_tr_b16 v[126:127], v42 offset:25608
    s_branch Lchk_3
Lpoll_1:
    buffer_load_dwordx4 v[22:25], v36, s[4:7], s52 offen offset:0 sc1
    buffer_load_dwordx4 v[26:29], v36, s[4:7], s52 offen offset:1024 sc1
Lchk_3:
    s_waitcnt vmcnt(0)
    v_xor_b32 v38, s40, v24
    v_bitop3_b32 v38, v28, s40, v38 bitop3:0xbe
    v_cmp_ne_u32 vcc, 0, v38
    s_cbranch_vccz Ldone_2
    s_sub_u32 s44, s44, 1
    s_cbranch_scc0 Lpoll_1
Ldone_2:
Lw_t1_4:
    s_cbranch_execz Lw_t1_8
    v_mfma_f32_16x16x16_bf16 v[64:67], v[56:57], v[22:23], 0
    v_mfma_f32_16x16x16_bf16 v[64:67], v[56:57], v[26:27], v[64:67]
    s_nop 7
    v_cvt_pk_bf16_f32 v80, v64, v65
    v_cvt_pk_bf16_f32 v81, v66, v67
    ds_write_b64 v49, v[80:81] offset:0
    s_waitcnt lgkmcnt(0)
    s_barrier
    ds_read_b128 v[128:131], v52 offset:0
    ds_read_b128 v[132:135], v52 offset:64
    ds_read_b128 v[136:139], v52 offset:128
    ds_read_b128 v[140:143], v52 offset:192
Lw_t1_5:
    s_cbranch_execz Lw_t1_9
    s_waitcnt lgkmcnt(3)
    v_mfma_f32_16x16x32_bf16 v[64:67], v[96:99], v[128:131], 0
    v_mfma_f32_16x16x32_bf16 v[68:71], v[112:115], v[128:131], 0
    s_waitcnt lgkmcnt(2)
    v_mfma_f32_16x16x32_bf16 v[64:67], v[100:103], v[132:135], v[64:67]
    v_mfma_f32_16x16x32_bf16 v[68:71], v[116:119], v[132:135], v[68:71]
    s_waitcnt lgkmcnt(1)
    v_mfma_f32_16x16x32_bf16 v[64:67], v[104:107], v[136:139], v[64:67]
    v_mfma_f32_16x16x32_bf16 v[68:71], v[120:123], v[136:139], v[68:71]
Lw_t1_6:
    s_cbranch_execz Lw_t1_10
    s_waitcnt lgkmcnt(0)
    v_mfma_f32_16x16x32_bf16 v[64:67], v[108:111], v[140:143], v[64:67]
    v_mfma_f32_16x16x32_bf16 v[68:71], v[124:127], v[140:143], v[68:71]
    s_mov_b32 exec_lo, 0xf000f
    s_mov_b32 exec_hi, 0xf000f
    s_nop 4
    v_cvt_pk_bf16_f32 v80, v64, v65
    v_cvt_pk_bf16_f32 v81, v66, v67
    v_cvt_pk_bf16_f32 v82, v68, v69
    v_cvt_pk_bf16_f32 v83, v70, v71
    v_cndmask_b32 v60, v80, v82, s[34:35]
    v_cndmask_b32 v61, v81, v83, s[34:35]
    buffer_store_dwordx4 v[60:63], v53, s[4:7], s53 offen
    s_mov_b64 exec, -1
    s_mov_b32 s44, 39999
    buffer_load_dwordx4 v[22:25], v36, s[4:7], s51 offen sc1
    s_cmp_ge_u32 s41, 2
    s_cbranch_scc1 Lt_nouk
    ds_read_b128 v[144:147], v44 offset:0
    ds_read_b128 v[160:163], v44 offset:1024
Lw_t1_7:
    s_cbranch_execz Lw_t1_11
    ds_read_b128 v[176:179], v44 offset:8192
    ds_read_b128 v[192:195], v44 offset:9216
    ds_read_b128 v[148:151], v45 offset:0
    ds_read_b128 v[164:167], v45 offset:1024
    ds_read_b128 v[180:183], v45 offset:8192
    ds_read_b128 v[196:199], v45 offset:9216
    ds_read_b128 v[152:155], v46 offset:0
    ds_read_b128 v[168:171], v46 offset:1024
    ds_read_b128 v[184:187], v46 offset:8192
    ds_read_b128 v[200:203], v46 offset:9216
    ds_read_b128 v[156:159], v47 offset:0
    ds_read_b128 v[172:175], v47 offset:1024
    ds_read_b128 v[188:191], v47 offset:8192
Lw_t1_8:
    s_cbranch_execz Lw_t1_12
    s_waitcnt lgkmcnt(7)
    ds_read_b128 v[204:207], v47 offset:9216
Lt_nouk:
    s_branch Lchk_6
Lpoll_4:
    s_and_b32 s3, s44, 31
    s_cselect_b32 s3, s51, s55
    s_cbranch_scc1 Lfast_7
    s_mov_b32 exec_lo, 0xf000f
    s_mov_b32 exec_hi, 0xf000f
    buffer_store_dwordx4 v[60:63], v53, s[4:7], s54 offen sc1
    s_mov_b64 exec, -1
Lfast_7:
    buffer_load_dwordx4 v[22:25], v36, s[4:7], s3 offen sc1
Lchk_6:
Lw_t1_9:
    s_cbranch_execz Lw_t1_13
    s_waitcnt vmcnt(0)
    v_xor_b32 v38, s40, v24
    v_cmp_ne_u32 vcc, 0, v38
    s_cbranch_vccz Ldone_5
    s_sub_u32 s44, s44, 1
    s_cbranch_scc0 Lpoll_4
Ldone_5:
    s_mov_b64 exec, 1
    buffer_store_dword v62, v36, s[4:7], s57 offen
    s_mov_b64 exec, -1
    v_mfma_f32_16x16x16_bf16 v[64:67], v[56:57], v[22:23], 0
    s_nop 7
    v_cvt_pk_bf16_f32 v80, v64, v65
    v_cvt_pk_bf16_f32 v81, v66, v67
    ds_write_b64 v49, v[80:81] offset:1024
Lw_t1_10:
    s_cbranch_execz Lw_t1_r
    s_waitcnt lgkmcnt(0)
    s_barrier
    s_cmp_ge_u32 s41, 2
    s_cbranch_scc1 Lt_noe3
    ds_read_b128 v[128:131], v52 offset:1024
    ds_read_b128 v[132:135], v52 offset:1088
    ds_read_b128 v[136:139], v52 offset:1152
    ds_read_b128 v[140:143], v52 offset:1216
    s_waitcnt lgkmcnt(3)
    v_mfma_f32_16x16x32_bf16 v[64:67], v[144:147], v[128:131], 0
Lw_t1_11:
    s_cbranch_execz Lw_t1_r
    v_mfma_f32_16x16x32_bf16 v[68:71], v[160:163], v[128:131], 0
    v_mfma_f32_16x16x32_bf16 v[72:75], v[176:179], v[128:131], 0
    v_mfma_f32_16x16x32_bf16 v[76:79], v[192:195], v[128:131], 0
    s_waitcnt lgkmcnt(2)
    v_mfma_f32_16x16x32_bf16 v[64:67], v[148:151], v[132:135], v[64:67]
    v_mfma_f32_16x16x32_bf16 v[68:71], v[164:167], v[132:135], v[68:71]
    v_mfma_f32_16x16x32_bf16 v[72:75], v[180:183], v[132:135], v[72:75]
    v_mfma_f32_16x16x32_bf16 v[76:79], v[196:199], v[132:135], v[76:79]
Lw_t1_12:
    s_cbranch_execz Lw_t1_r
    s_waitcnt lgkmcnt(1)
    v_mfma_f32_16x16x32_bf16 v[64:67], v[152:155], v[136:139], v[64:67]
    v_mfma_f32_16x16x32_bf16 v[68:71], v[168:171], v[136:139], v[68:71]
    v_mfma_f32_16x16x32_bf16 v[72:75], v[184:187], v[136:139], v[72:75]
    v_mfma_f32_16x16x32_bf16 v[76:79], v[200:203], v[136:139], v[76:79]
    s_waitcnt lgkmcnt(0)
    v_mfma_f32_16x16x32_bf16 v[64:67], v[156:159], v[140:143], v[64:67]
    v_mfma_f32_16x16x32_bf16 v[68:71], v[172:175], v[140:143], v[68:71]
    v_mfma_f32_16x16x32_bf16 v[72:75], v[188:191], v[140:143], v[72:75]
Lw_t1_13:
    s_cbranch_execz Lw_t1_r
    v_mfma_f32_16x16x32_bf16 v[76:79], v[204:207], v[140:143], v[76:79]
    s_mov_b32 exec_lo, 0xf000f
    s_mov_b32 exec_hi, 0xf000f
    s_nop 1
    v_cvt_pk_bf16_f32 v80, v64, v65
    v_cvt_pk_bf16_f32 v81, v66, v67
    v_cvt_pk_bf16_f32 v82, v68, v69
    v_cvt_pk_bf16_f32 v83, v70, v71
    v_cvt_pk_bf16_f32 v84, v72, v73
    v_cvt_pk_bf16_f32 v85, v74, v75
    v_cvt_pk_bf16_f32 v86, v76, v77
    v_cvt_pk_bf16_f32 v87, v78, v79
    v_cndmask_b32 v88, v80, v84, s[34:35]
    v_cndmask_b32 v89, v81, v85, s[34:35]
    v_cndmask_b32 v90, v82, v86, s[34:35]
    v_cndmask_b32 v91, v83, v87, s[34:35]
    v_min_u32 v88, -2, v88
    buffer_store_dwordx4 v[88:91], v55, s[4:7], s56 offen sc1
    s_mov_b64 exec, -1
Lt_noe3:
    s_barrier
    s_mov_b32 exec_lo, 0xf000f
    s_mov_b32 exec_hi, 0xf000f
    buffer_store_dwordx4 v[60:63], v53, s[4:7], s54 offen sc1
    s_mov_b64 exec, -1
    s_mov_b64 exec, 1
    buffer_store_dword v62, v36, s[4:7], s57 offen offset:2048 sc1
    s_mov_b64 exec, -1
    s_bfe_u32 s3, s42, 0x20008
    s_lshl_b32 s3, s3, 11
    s_add_u32 m0, s3, 98304
    s_nop 0
    buffer_load_dwordx4 v34, s[28:31], s45 offen nt lds
    buffer_load_dwordx4 v35, s[28:31], s45 offen offset:1024 nt lds
    s_add_u32 m0, m0, 8192
    s_add_u32 s45, s45, 32768
    buffer_load_dwordx4 v34, s[28:31], s45 offen nt lds
    buffer_load_dwordx4 v35, s[28:31], s45 offen offset:1024 nt lds
    s_add_u32 m0, m0, 8192
    s_add_u32 s45, s45, 32768
    buffer_load_dwordx4 v34, s[28:31], s45 offen nt lds
    buffer_load_dwordx4 v35, s[28:31], s45 offen offset:1024 nt lds
    s_add_u32 m0, m0, 8192
    s_add_u32 s45, s45, 32768
    buffer_load_dwordx4 v34, s[28:31], s45 offen nt lds
    buffer_load_dwordx4 v35, s[28:31], s45 offen offset:1024 nt lds
    s_cmp_lt_u32 s43, 8
    s_cbranch_scc1 Lt_nomod2a
    buffer_load_dwordx2 v[6:7], v2, s[12:15], 0 offen
    s_bfe_u32 s3, s42, 0x20008
    s_mul_i32 s3, s3, 786432
    s_add_u32 s45, s3, 2048
    s_bfe_u32 s3, s42, 0x30000
    s_lshl_b32 s3, s3, 9
    s_add_u32 s45, s3, s45
    s_bfe_u32 s3, s42, 0x30003
    s_lshl_b32 s3, s3, 6
    s_add_u32 s45, s3, s45
    s_bfe_u32 s3, s42, 0x20008
    s_lshl_b32 s3, s3, 13
    s_add_u32 m0, s3, 65536
    s_mov_b32 s3, 8
Ldma_8:
    buffer_load_dwordx4 v3, s[16:19], s45 offen offset:0 nt lds
    s_add_u32 m0, m0, 1024
    s_add_u32 s45, s45, 98304
    s_sub_u32 s3, s3, 1
    s_cmp_lg_u32 s3, 0
    s_cbranch_scc1 Ldma_8
    s_waitcnt vmcnt(8)
    v_lshlrev_b32 v80, 16, v6
    v_and_b32 v81, 0xffff0000, v6
    v_lshlrev_b32 v82, 16, v7
    v_and_b32 v83, 0xffff0000, v7
    v_mul_f32 v84, 0xbfb8aa3b, v80
    v_mul_f32 v85, 0xbfb8aa3b, v81
    v_mul_f32 v86, 0xbfb8aa3b, v82
    v_mul_f32 v87, 0xbfb8aa3b, v83
    v_exp_f32 v84, v84
    v_exp_f32 v85, v85
    v_exp_f32 v86, v86
    v_exp_f32 v87, v87
    v_add_f32 v84, 1.0, v84
    v_add_f32 v85, 1.0, v85
    v_add_f32 v86, 1.0, v86
    v_add_f32 v87, 1.0, v87
    v_rcp_f32 v84, v84
    v_rcp_f32 v85, v85
    v_rcp_f32 v86, v86
    v_rcp_f32 v87, v87
    v_mul_f32 v80, v80, v84
    v_mul_f32 v81, v81, v85
    v_mul_f32 v82, v82, v86
    v_mul_f32 v83, v83, v87
    v_cvt_pk_bf16_f32 v84, v80, v81
    v_cvt_pk_bf16_f32 v85, v82, v83
    ds_write_b64 v212, v[84:85]
    s_branch Lt_ta
Lt_nomod2a:
    s_waitcnt lgkmcnt(0)
    s_mov_b32 s46, s58
    s_add_u32 m0, s62, 0
    s_nop 0
    buffer_load_dwordx4 v4, s[20:23], s46 offen nt lds
    s_add_u32 s46, s46, s60
    s_add_u32 m0, s62, 1024
    s_nop 0
    buffer_load_dwordx4 v4, s[20:23], s46 offen nt lds
    s_add_u32 s46, s46, s60
    s_add_u32 m0, s62, 2048
    s_nop 0
    buffer_load_dwordx4 v4, s[20:23], s46 offen nt lds
    s_add_u32 s46, s46, s60
    s_add_u32 m0, s62, 3072
    s_nop 0
    buffer_load_dwordx4 v4, s[20:23], s46 offen nt lds
    s_add_u32 s46, s46, s60
    s_add_u32 m0, s62, 4096
    s_nop 0
    buffer_load_dwordx4 v4, s[20:23], s46 offen nt lds
    s_add_u32 s46, s46, s60
    s_add_u32 m0, s62, 5120
    s_nop 0
    buffer_load_dwordx4 v4, s[20:23], s46 offen nt lds
    s_add_u32 s46, s46, s60
    s_add_u32 m0, s62, 6144
    s_nop 0
    buffer_load_dwordx4 v4, s[20:23], s46 offen nt lds
    s_add_u32 s46, s46, s60
    s_add_u32 m0, s62, 7168
    s_nop 0
    buffer_load_dwordx4 v4, s[20:23], s46 offen nt lds
    s_mov_b32 s46, s59
    s_add_u32 m0, s62, 32768
    s_nop 0
    buffer_load_dwordx4 v5, s[24:27], s46 offen nt lds
    s_add_u32 s46, s46, s61
    s_add_u32 m0, s62, 33792
    s_nop 0
    buffer_load_dwordx4 v5, s[24:27], s46 offen nt lds
    s_add_u32 s46, s46, s61
    s_add_u32 m0, s62, 34816
    s_nop 0
    buffer_load_dwordx4 v5, s[24:27], s46 offen nt lds
    s_add_u32 s46, s46, s61
    s_add_u32 m0, s62, 35840
    s_nop 0
    buffer_load_dwordx4 v5, s[24:27], s46 offen nt lds
    s_add_u32 s46, s46, s61
    s_add_u32 m0, s62, 36864
    s_nop 0
    buffer_load_dwordx4 v5, s[24:27], s46 offen nt lds
    s_add_u32 s46, s46, s61
    s_add_u32 m0, s62, 37888
    s_nop 0
    buffer_load_dwordx4 v5, s[24:27], s46 offen nt lds
    s_add_u32 s46, s46, s61
    s_add_u32 m0, s62, 38912
    s_nop 0
    buffer_load_dwordx4 v5, s[24:27], s46 offen nt lds
    s_add_u32 s46, s46, s61
    s_add_u32 m0, s62, 39936
    s_nop 0
    buffer_load_dwordx4 v5, s[24:27], s46 offen nt lds
Lt_ta:
    v_lshlrev_b32 v216, 4, v51
    s_mov_b32 s3, 0x3f80
    v_lshlrev_b32 v216, v216, s3
    v_cmp_eq_u32 vcc, 0, v50
    s_nop 1
    v_cndmask_b32 v10, 0, v216, vcc
    v_cmp_eq_u32 vcc, 1, v50
    s_nop 1
    v_cndmask_b32 v11, 0, v216, vcc
    v_cmp_eq_u32 vcc, 2, v50
    s_nop 1
    v_cndmask_b32 v12, 0, v216, vcc
    v_cmp_eq_u32 vcc, 3, v50
    s_nop 1
    v_cndmask_b32 v13, 0, v216, vcc
    v_cmp_eq_u32 vcc, 4, v50
    s_nop 1
    v_cndmask_b32 v14, 0, v216, vcc
    v_cmp_eq_u32 vcc, 5, v50
    s_nop 1
    v_cndmask_b32 v15, 0, v216, vcc
    v_cmp_eq_u32 vcc, 6, v50
    s_nop 1
    v_cndmask_b32 v16, 0, v216, vcc
    v_cmp_eq_u32 vcc, 7, v50
    s_nop 1
    v_cndmask_b32 v17, 0, v216, vcc
    s_mov_b32 s3, 98304
    v_lshl_add_u32 v217, v31, 4, s3
    s_mov_b32 s3, 1056
    v_mad_u32_u24 v217, v51, s3, v217
    v_bfe_u32 v218, v0, 3, 2
    v_xor_b32 v38, v218, v32
    v_lshlrev_b32 v219, 11, v208
    v_lshl_add_u32 v219, v209, 9, v219
    v_lshl_add_u32 v219, v41, 7, v219
    v_lshl_add_u32 v219, v38, 5, v219
    v_lshl_add_u32 v219, v39, 3, v219
    s_mov_b32 s3, 98304
    v_lshl_add_u32 v220, v32, 8, s3
    v_lshl_add_u32 v220, v208, 7, v220
    v_bfe_u32 v221, v0, 3, 1
    v_lshl_add_u32 v220, v221, 6, v220
    v_lshl_add_u32 v220, v54, 5, v220
    v_lshl_add_u32 v220, v209, 4, v220
    v_lshl_add_u32 v220, v51, 3, v220
    v_bfe_u32 v222, v0, 2, 1
    s_mov_b32 s3, 1056
    v_mad_u32_u24 v220, v222, s3, v220
    v_lshlrev_b32 v223, 4, v31
    s_bfe_u32 s3, s42, 0x30000
    s_lshl_b32 s3, s3, 13
    s_add_u32 s58, s3, 327680
    s_bfe_u32 s3, s42, 0x20008
    s_lshl_b32 s3, s3, 11
    s_add_u32 s58, s3, s58
    s_bfe_u32 s3, s42, 0x30000
    s_lshl_b32 s3, s3, 11
    s_add_u32 s60, s3, 49152
    s_bfe_u32 s3, s42, 0x30003
    s_lshl_b32 s3, s3, 8
    s_add_u32 s60, s3, s60
    s_bfe_u32 s3, s42, 0x20008
    s_lshl_b32 s3, s3, 6
    s_add_u32 s60, s3, s60
    s_add_u32 s59, s58, 327680
    s_mov_b32 s3, 131072
    v_lshl_add_u32 v224, v31, 4, s3
    s_mov_b32 s3, 1056
    v_mad_u32_u24 v224, v51, s3, v224
    v_xor_b32 v38, v209, v48
    s_mov_b32 s3, 65536
    v_lshl_add_u32 v225, v31, 9, s3
    v_lshl_add_u32 v225, v41, 6, v225
    v_lshl_add_u32 v225, v38, 5, v225
    v_lshl_add_u32 v225, v39, 3, v225
    v_lshlrev_b32 v226, 6, v51
    v_lshl_add_u32 v226, v48, 5, v226
    v_lshl_add_u32 v226, v31, 3, v226
    v_xor_b32 v38, v221, v48
    v_lshlrev_b32 v227, 15, v213
    v_lshl_add_u32 v227, v38, 14, v227
    v_lshl_add_u32 v227, v214, 11, v227
    v_lshl_add_u32 v227, v31, 9, v227
    s_bfe_u32 s3, s42, 0x30000
    s_lshl_b32 s3, s3, 6
    s_add_u32 s47, s3, 262144
    s_bfe_u32 s3, s42, 0x20005
    s_lshl_b32 s3, s3, 4
    s_add_u32 s47, s3, s47
    s_bfe_u32 s3, s42, 0x30000
    s_lshl_b32 s3, s3, 19
    s_add_u32 s52, s3, 1048576
    s_bfe_u32 s3, s42, 0x40003
    s_lshl_b32 s3, s3, 15
    s_add_u32 s52, s3, s52
    s_bfe_u32 s3, s42, 0x20008
    s_lshl_b32 s3, s3, 13
    s_add_u32 s52, s3, s52
    s_add_u32 s53, s52, 4096
    v_add_u32 v42, 98304, v42
    s_mov_b32 s3, 135424
    v_lshl_add_u32 v228, v33, 4, s3
    v_lshl_add_u32 v228, v209, 3, v228
    s_mov_b32 s3, 288
    v_mad_u32_u24 v228, v32, s3, v228
    s_mov_b32 s3, 135424
    v_lshl_add_u32 v229, v31, 4, s3
    s_mov_b32 s3, 288
    v_mad_u32_u24 v229, v39, s3, v229
    v_lshlrev_b32 v230, 6, v54
    v_lshl_add_u32 v230, v31, 4, v230
    v_bfe_u32 v231, v0, 1, 2
    v_lshlrev_b32 v236, 4, v51
    s_mov_b32 s3, 0xffff
    v_lshlrev_b32 v236, v236, s3
    v_cmp_eq_u32 vcc, 0, v231
    s_nop 1
    v_cndmask_b32 v232, 0, v236, vcc
    v_cmp_eq_u32 vcc, 1, v231
    s_nop 1
    v_cndmask_b32 v233, 0, v236, vcc
    v_cmp_eq_u32 vcc, 2, v231
    s_nop 1
    v_cndmask_b32 v234, 0, v236, vcc
    v_cmp_eq_u32 vcc, 3, v231
    s_nop 1
    v_cndmask_b32 v235, 0, v236, vcc
    s_mov_b64 exec, 0
    s_cmp_eq_u32 s41, 0
    s_cbranch_scc1 Lw_t2_0
    s_cmp_eq_u32 s41, 1
    s_cbranch_scc1 Lw_t2_1
    s_cmp_eq_u32 s41, 2
    s_cbranch_scc1 Lw_t2_2
    s_cmp_eq_u32 s41, 3
    s_cbranch_scc1 Lw_t2_3
Lw_t2_r:
    s_mov_b64 exec, -1
    s_waitcnt vmcnt(0) lgkmcnt(0)
    s_barrier
    s_and_b32 s3, s42, 0x240
    s_cmp_lg_u32 s3, 0x40
    s_cbranch_scc1 Lt_nomod2b
    ds_read_b64_tr_b16 v[144:145], v225 offset:0
    ds_read_b64_tr_b16 v[146:147], v225 offset:256
    ds_read_b128 v[164:167], v224 offset:0
    ds_read_b64_tr_b16 v[148:149], v225 offset:2048
    ds_read_b64_tr_b16 v[150:151], v225 offset:2304
    ds_read_b128 v[168:171], v224 offset:64
    ds_read_b64_tr_b16 v[152:153], v225 offset:4096
    ds_read_b64_tr_b16 v[154:155], v225 offset:4352
    ds_read_b128 v[172:175], v224 offset:128
    ds_read_b64_tr_b16 v[156:157], v225 offset:6144
    ds_read_b64_tr_b16 v[158:159], v225 offset:6400
    ds_read_b128 v[176:179], v224 offset:192
Lw_t2_0:
    s_cbranch_execz Lw_t2_4
    s_waitcnt lgkmcnt(9)
    v_mfma_f32_16x16x32_bf16 v[64:67], v[144:147], v[164:167], 0
    ds_read_b64_tr_b16 v[160:161], v225 offset:8192
    ds_read_b64_tr_b16 v[162:163], v225 offset:8448
    ds_read_b128 v[180:183], v224 offset:256
    s_waitcnt lgkmcnt(9)
    v_mfma_f32_16x16x32_bf16 v[64:67], v[148:151], v[168:171], v[64:67]
    ds_read_b64_tr_b16 v[144:145], v225 offset:10240
    ds_read_b64_tr_b16 v[146:147], v225 offset:10496
    ds_read_b128 v[164:167], v224 offset:320
Lw_t2_1:
    s_cbranch_execz Lw_t2_5
    s_waitcnt lgkmcnt(9)
    v_mfma_f32_16x16x32_bf16 v[64:67], v[152:155], v[172:175], v[64:67]
    ds_read_b64_tr_b16 v[148:149], v225 offset:12288
    ds_read_b64_tr_b16 v[150:151], v225 offset:12544
    ds_read_b128 v[168:171], v224 offset:384
    s_waitcnt lgkmcnt(9)
    v_mfma_f32_16x16x32_bf16 v[64:67], v[156:159], v[176:179], v[64:67]
    ds_read_b64_tr_b16 v[152:153], v225 offset:14336
    ds_read_b64_tr_b16 v[154:155], v225 offset:14592
    ds_read_b128 v[172:175], v224 offset:448
Lw_t2_2:
    s_cbranch_execz Lw_t2_6
    s_waitcnt lgkmcnt(9)
    v_mfma_f32_16x16x32_bf16 v[64:67], v[160:163], v[180:183], v[64:67]
    ds_read_b64_tr_b16 v[156:157], v225 offset:16384
    ds_read_b64_tr_b16 v[158:159], v225 offset:16640
    ds_read_b128 v[176:179], v224 offset:512
    s_waitcnt lgkmcnt(9)
    v_mfma_f32_16x16x32_bf16 v[64:67], v[144:147], v[164:167], v[64:67]
    ds_read_b64_tr_b16 v[160:161], v225 offset:18432
    ds_read_b64_tr_b16 v[162:163], v225 offset:18688
    ds_read_b128 v[180:183], v224 offset:576
Lw_t2_3:
    s_cbranch_execz Lw_t2_7
    s_waitcnt lgkmcnt(9)
    v_mfma_f32_16x16x32_bf16 v[64:67], v[148:151], v[168:171], v[64:67]
    ds_read_b64_tr_b16 v[144:145], v225 offset:20480
    ds_read_b64_tr_b16 v[146:147], v225 offset:20736
    ds_read_b128 v[164:167], v224 offset:640
    s_waitcnt lgkmcnt(9)
    v_mfma_f32_16x16x32_bf16 v[64:67], v[152:155], v[172:175], v[64:67]
    ds_read_b64_tr_b16 v[148:149], v225 offset:22528
    ds_read_b64_tr_b16 v[150:151], v225 offset:22784
    ds_read_b128 v[168:171], v224 offset:704
Lw_t2_4:
    s_cbranch_execz Lw_t2_8
    s_waitcnt lgkmcnt(9)
    v_mfma_f32_16x16x32_bf16 v[64:67], v[156:159], v[176:179], v[64:67]
    ds_read_b64_tr_b16 v[152:153], v225 offset:24576
    ds_read_b64_tr_b16 v[154:155], v225 offset:24832
    ds_read_b128 v[172:175], v224 offset:768
    s_waitcnt lgkmcnt(9)
    v_mfma_f32_16x16x32_bf16 v[64:67], v[160:163], v[180:183], v[64:67]
    ds_read_b64_tr_b16 v[156:157], v225 offset:26624
    ds_read_b64_tr_b16 v[158:159], v225 offset:26880
    ds_read_b128 v[176:179], v224 offset:832
Lw_t2_5:
    s_cbranch_execz Lw_t2_9
    s_waitcnt lgkmcnt(9)
    v_mfma_f32_16x16x32_bf16 v[64:67], v[144:147], v[164:167], v[64:67]
    ds_read_b64_tr_b16 v[160:161], v225 offset:28672
    ds_read_b64_tr_b16 v[162:163], v225 offset:28928
    ds_read_b128 v[180:183], v224 offset:896
    s_waitcnt lgkmcnt(9)
    v_mfma_f32_16x16x32_bf16 v[64:67], v[148:151], v[168:171], v[64:67]
    ds_read_b64_tr_b16 v[144:145], v225 offset:30720
    ds_read_b64_tr_b16 v[146:147], v225 offset:30976
    ds_read_b128 v[164:167], v224 offset:960
Lw_t2_6:
    s_cbranch_execz Lw_t2_10
    s_waitcnt lgkmcnt(9)
    v_mfma_f32_16x16x32_bf16 v[64:67], v[152:155], v[172:175], v[64:67]
    s_waitcnt lgkmcnt(6)
    v_mfma_f32_16x16x32_bf16 v[64:67], v[156:159], v[176:179], v[64:67]
    s_waitcnt lgkmcnt(3)
    v_mfma_f32_16x16x32_bf16 v[64:67], v[160:163], v[180:183], v[64:67]
    s_waitcnt lgkmcnt(0)
    v_mfma_f32_16x16x32_bf16 v[64:67], v[144:147], v[164:167], v[64:67]
    s_mov_b32 exec_lo, 0x30003
    s_mov_b32 exec_hi, 0x30003
    s_nop 5
    v_cvt_pk_bf16_f32 v80, v64, v65
    v_cvt_pk_bf16_f32 v81, v66, v67
    v_min_u32 v80, -2, v80
    buffer_store_dwordx2 v[80:81], v226, s[4:7], s50 offen sc1
    s_mov_b64 exec, -1
Lt_nomod2b:
    s_cmp_ge_u32 s43, 8
    s_cbranch_scc1 Lt_tb
    ds_read_b64_tr_b16 a[64:65], v219 offset:0
    ds_read_b64_tr_b16 a[66:67], v219 offset:1024
    ds_read_b64_tr_b16 a[68:69], v219 offset:4096
Lw_t2_7:
    s_cbranch_execz Lw_t2_11
    ds_read_b64_tr_b16 a[70:71], v219 offset:5120
    ds_read_b64_tr_b16 a[72:73], v219 offset:8192
    ds_read_b64_tr_b16 a[74:75], v219 offset:9216
    ds_read_b64_tr_b16 a[76:77], v219 offset:12288
    ds_read_b64_tr_b16 a[78:79], v219 offset:13312
    ds_read_b64_tr_b16 a[80:81], v219 offset:16384
    ds_read_b64_tr_b16 a[82:83], v219 offset:17408
    ds_read_b64_tr_b16 a[84:85], v219 offset:20480
    ds_read_b64_tr_b16 a[86:87], v219 offset:21504
    ds_read_b64_tr_b16 a[88:89], v219 offset:24576
    ds_read_b64_tr_b16 a[90:91], v219 offset:25600
    ds_read_b64_tr_b16 a[92:93], v219 offset:28672
Lw_t2_8:
    s_cbranch_execz Lw_t2_12
    s_waitcnt lgkmcnt(7)
    ds_read_b64_tr_b16 a[94:95], v219 offset:29696
    ds_read_b64_tr_b16 a[96:97], v219 offset:32768
    ds_read_b64_tr_b16 a[98:99], v219 offset:33792
    ds_read_b64_tr_b16 a[100:101], v219 offset:36864
    ds_read_b64_tr_b16 a[102:103], v219 offset:37888
    ds_read_b64_tr_b16 a[104:105], v219 offset:40960
    ds_read_b64_tr_b16 a[106:107], v219 offset:41984
    ds_read_b64_tr_b16 a[108:109], v219 offset:45056
Lw_t2_9:
    s_cbranch_execz Lw_t2_13
    s_waitcnt lgkmcnt(7)
    ds_read_b64_tr_b16 a[110:111], v219 offset:46080
    ds_read_b64_tr_b16 a[112:113], v219 offset:49152
    ds_read_b64_tr_b16 a[114:115], v219 offset:50176
    ds_read_b64_tr_b16 a[116:117], v219 offset:53248
    ds_read_b64_tr_b16 a[118:119], v219 offset:54272
    ds_read_b64_tr_b16 a[120:121], v219 offset:57344
    ds_read_b64_tr_b16 a[122:123], v219 offset:58368
    ds_read_b64_tr_b16 a[124:125], v219 offset:61440
Lw_t2_10:
    s_cbranch_execz Lw_t2_14
    s_waitcnt lgkmcnt(7)
    ds_read_b64_tr_b16 a[126:127], v219 offset:62464
    s_waitcnt lgkmcnt(0)
Lt_tb:
    ds_read_b64_tr_b16 v[96:97], v42 offset:0
    ds_read_b64_tr_b16 v[98:99], v42 offset:1024
    ds_read_b64_tr_b16 v[112:113], v42 offset:8
    ds_read_b64_tr_b16 v[114:115], v42 offset:1032
    ds_read_b64_tr_b16 v[100:101], v42 offset:8192
    ds_read_b64_tr_b16 v[102:103], v42 offset:9216
    ds_read_b64_tr_b16 v[116:117], v42 offset:8200
    ds_read_b64_tr_b16 v[118:119], v42 offset:9224
    ds_read_b64_tr_b16 v[104:105], v42 offset:16384
    ds_read_b64_tr_b16 v[106:107], v42 offset:17408
    ds_read_b64_tr_b16 v[120:121], v42 offset:16392
    ds_read_b64_tr_b16 v[122:123], v42 offset:17416
    ds_read_b64_tr_b16 v[108:109], v42 offset:24576
    ds_read_b64_tr_b16 v[110:111], v42 offset:25600
Lw_t2_11:
    s_cbranch_execz Lw_t2_15
    ds_read_b64_tr_b16 v[124:125], v42 offset:24584
    s_waitcnt lgkmcnt(7)
    ds_read_b64_tr_b16 v[126:127], v42 offset:25608
    s_mov_b32 s44, 39999
    buffer_load_dwordx4 v[22:25], v227, s[4:7], s47 offen sc1
Lchk_10:
    s_waitcnt vmcnt(0)
    v_xor_b32 v38, s40, v24
    v_cmp_ne_u32 vcc, 0, v38
    s_cbranch_vccz Ldone_9
    s_mov_b64 exec, vcc
    buffer_load_dwordx4 v[22:25], v227, s[4:7], s47 offen sc1
    s_mov_b64 exec, -1
    s_sub_u32 s44, s44, 1
    s_cbranch_scc0 Lchk_10
Ldone_9:
    s_mov_b32 s44, 39999
    buffer_load_dwordx4 v[144:147], v36, s[4:7], s52 offen offset:0 sc1
    buffer_load_dwordx4 v[148:151], v36, s[4:7], s52 offen offset:1024 sc1
    buffer_load_dwordx4 v[152:155], v36, s[4:7], s52 offen offset:2048 sc1
    buffer_load_dwordx4 v[156:159], v36, s[4:7], s52 offen offset:3072 sc1
    buffer_load_dwordx4 v[160:163], v36, s[4:7], s53 offen offset:0 sc1
Lw_t2_12:
    s_cbranch_execz Lw_t2_16
    buffer_load_dwordx4 v[164:167], v36, s[4:7], s53 offen offset:1024 sc1
    buffer_load_dwordx4 v[168:171], v36, s[4:7], s53 offen offset:2048 sc1
    buffer_load_dwordx4 v[172:175], v36, s[4:7], s53 offen offset:3072 sc1
    v_mov_b32 v80, v22
    s_nop 1
    v_max_f32_dpp v80, v80, v80 quad_perm:[1,0,3,2] row_mask:0xf bank_mask:0xf
    s_nop 1
    v_max_f32_dpp v80, v80, v80 quad_perm:[2,3,0,1] row_mask:0xf bank_mask:0xf
    s_nop 1
    v_max_f32_dpp v80, v80, v80 row_half_mirror row_mask:0xf bank_mask:0xf
    s_nop 1
    v_max_f32_dpp v80, v80, v80 row_mirror row_mask:0xf bank_mask:0xf
    v_mov_b32 v81, v80
    s_nop 1
    v_permlane16_swap_b32 v80, v81
    v_max_f32 v80, v80, v81
    v_mov_b32 v81, v80
    s_nop 1
    v_permlane32_swap_b32 v80, v81
    v_max_f32 v80, v80, v81
    v_sub_f32 v22, v22, v80
    v_exp_f32 v22, v22
    s_nop 0
    v_mul_f32 v80, v22, v23
    s_nop 1
    v_add_f32_dpp v80, v80, v80 quad_perm:[1,0,3,2] row_mask:0xf bank_mask:0xf
    s_nop 1
    v_add_f32_dpp v80, v80, v80 quad_perm:[2,3,0,1] row_mask:0xf bank_mask:0xf
    s_nop 1
    v_add_f32_dpp v80, v80, v80 row_half_mirror row_mask:0xf bank_mask:0xf
    s_nop 1
    v_add_f32_dpp v80, v80, v80 row_mirror row_mask:0xf bank_mask:0xf
Lw_t2_13:
    s_cbranch_execz Lw_t2_17
    v_mov_b32 v81, v80
    s_nop 1
    v_permlane16_swap_b32 v80, v81
    v_add_f32 v80, v80, v81
    v_mov_b32 v81, v80
    s_nop 1
    v_permlane32_swap_b32 v80, v81
    v_add_f32 v80, v80, v81
    v_rcp_f32 v80, v80
    s_nop 0
    v_mul_f32 v22, v22, v80
    v_cvt_pk_bf16_f32 v80, v22, v22
    s_nop 1
    v_and_b32_dpp v176, v80, v232 row_newbcast:0 row_mask:0xf bank_mask:0xf
    v_and_b32_dpp v177, v80, v233 row_newbcast:0 row_mask:0xf bank_mask:0xf
    v_and_b32_dpp v178, v80, v234 row_newbcast:0 row_mask:0xf bank_mask:0xf
    v_and_b32_dpp v179, v80, v235 row_newbcast:0 row_mask:0xf bank_mask:0xf
    v_and_b32_dpp v180, v80, v232 row_newbcast:1 row_mask:0xf bank_mask:0xf
    v_and_b32_dpp v181, v80, v233 row_newbcast:1 row_mask:0xf bank_mask:0xf
    v_and_b32_dpp v182, v80, v234 row_newbcast:1 row_mask:0xf bank_mask:0xf
    v_and_b32_dpp v183, v80, v235 row_newbcast:1 row_mask:0xf bank_mask:0xf
    v_and_b32_dpp v184, v80, v232 row_newbcast:2 row_mask:0xf bank_mask:0xf
    v_and_b32_dpp v185, v80, v233 row_newbcast:2 row_mask:0xf bank_mask:0xf
    v_and_b32_dpp v186, v80, v234 row_newbcast:2 row_mask:0xf bank_mask:0xf
Lw_t2_14:
    s_cbranch_execz Lw_t2_18
    v_and_b32_dpp v187, v80, v235 row_newbcast:2 row_mask:0xf bank_mask:0xf
    v_and_b32_dpp v188, v80, v232 row_newbcast:3 row_mask:0xf bank_mask:0xf
    v_and_b32_dpp v189, v80, v233 row_newbcast:3 row_mask:0xf bank_mask:0xf
    v_and_b32_dpp v190, v80, v234 row_newbcast:3 row_mask:0xf bank_mask:0xf
    v_and_b32_dpp v191, v80, v235 row_newbcast:3 row_mask:0xf bank_mask:0xf
    v_and_b32_dpp v192, v80, v232 row_newbcast:4 row_mask:0xf bank_mask:0xf
    v_and_b32_dpp v193, v80, v233 row_newbcast:4 row_mask:0xf bank_mask:0xf
    v_and_b32_dpp v194, v80, v234 row_newbcast:4 row_mask:0xf bank_mask:0xf
    v_and_b32_dpp v195, v80, v235 row_newbcast:4 row_mask:0xf bank_mask:0xf
    v_and_b32_dpp v196, v80, v232 row_newbcast:5 row_mask:0xf bank_mask:0xf
    v_and_b32_dpp v197, v80, v233 row_newbcast:5 row_mask:0xf bank_mask:0xf
    v_and_b32_dpp v198, v80, v234 row_newbcast:5 row_mask:0xf bank_mask:0xf
    v_and_b32_dpp v199, v80, v235 row_newbcast:5 row_mask:0xf bank_mask:0xf
    v_and_b32_dpp v200, v80, v232 row_newbcast:6 row_mask:0xf bank_mask:0xf
    v_and_b32_dpp v201, v80, v233 row_newbcast:6 row_mask:0xf bank_mask:0xf
    v_and_b32_dpp v202, v80, v234 row_newbcast:6 row_mask:0xf bank_mask:0xf
Lw_t2_15:
    s_cbranch_execz Lw_t2_19
    v_and_b32_dpp v203, v80, v235 row_newbcast:6 row_mask:0xf bank_mask:0xf
    v_and_b32_dpp v204, v80, v232 row_newbcast:7 row_mask:0xf bank_mask:0xf
    v_and_b32_dpp v205, v80, v233 row_newbcast:7 row_mask:0xf bank_mask:0xf
    v_and_b32_dpp v206, v80, v234 row_newbcast:7 row_mask:0xf bank_mask:0xf
    v_and_b32_dpp v207, v80, v235 row_newbcast:7 row_mask:0xf bank_mask:0xf
Lchk_12:
    s_waitcnt vmcnt(0)
    v_max_u32 v38, v144, v148
    v_max3_u32 v38, v38, v152, v156
    v_max3_u32 v38, v38, v160, v164
    v_max3_u32 v38, v38, v168, v172
    v_cmp_eq_u32 vcc, -1, v38
    s_cbranch_vccz Ldone_11
    v_cmp_eq_u32 vcc, -1, v144
    s_mov_b64 exec, vcc
    buffer_load_dwordx4 v[144:147], v36, s[4:7], s52 offen offset:0 sc1
    s_mov_b64 exec, -1
    v_cmp_eq_u32 vcc, -1, v148
    s_mov_b64 exec, vcc
    buffer_load_dwordx4 v[148:151], v36, s[4:7], s52 offen offset:1024 sc1
    s_mov_b64 exec, -1
    v_cmp_eq_u32 vcc, -1, v152
Lw_t2_16:
    s_cbranch_execz Lw_t2_20
    s_mov_b64 exec, vcc
    buffer_load_dwordx4 v[152:155], v36, s[4:7], s52 offen offset:2048 sc1
    s_mov_b64 exec, -1
    v_cmp_eq_u32 vcc, -1, v156
    s_mov_b64 exec, vcc
    buffer_load_dwordx4 v[156:159], v36, s[4:7], s52 offen offset:3072 sc1
    s_mov_b64 exec, -1
    v_cmp_eq_u32 vcc, -1, v160
    s_mov_b64 exec, vcc
    buffer_load_dwordx4 v[160:163], v36, s[4:7], s53 offen offset:0 sc1
    s_mov_b64 exec, -1
    v_cmp_eq_u32 vcc, -1, v164
    s_mov_b64 exec, vcc
    buffer_load_dwordx4 v[164:167], v36, s[4:7], s53 offen offset:1024 sc1
    s_mov_b64 exec, -1
    v_cmp_eq_u32 vcc, -1, v168
    s_mov_b64 exec, vcc
    buffer_load_dwordx4 v[168:171], v36, s[4:7], s53 offen offset:2048 sc1
    s_mov_b64 exec, -1
    v_cmp_eq_u32 vcc, -1, v172
    s_mov_b64 exec, vcc
    buffer_load_dwordx4 v[172:175], v36, s[4:7], s53 offen offset:3072 sc1
    s_mov_b64 exec, -1
    s_sub_u32 s44, s44, 1
    s_cbranch_scc0 Lchk_12
Ldone_11:
Lw_t2_17:
    s_cbranch_execz Lw_t2_21
    v_mfma_f32_16x16x32_bf16 v[64:67], v[176:179], v[144:147], 0
    v_mfma_f32_16x16x32_bf16 v[64:67], v[180:183], v[148:151], v[64:67]
    v_mfma_f32_16x16x32_bf16 v[64:67], v[184:187], v[152:155], v[64:67]
    v_mfma_f32_16x16x32_bf16 v[64:67], v[188:191], v[156:159], v[64:67]
    v_mfma_f32_16x16x32_bf16 v[64:67], v[192:195], v[160:163], v[64:67]
    v_mfma_f32_16x16x32_bf16 v[64:67], v[196:199], v[164:167], v[64:67]
    v_mfma_f32_16x16x32_bf16 v[64:67], v[200:203], v[168:171], v[64:67]
    v_mfma_f32_16x16x32_bf16 v[64:67], v[204:207], v[172:175], v[64:67]
    s_nop 7
    v_cvt_pk_bf16_f32 v80, v64, v65
    v_cvt_pk_bf16_f32 v81, v66, v67
    ds_write_b64 v228, v[80:81]
Lw_t2_18:
    s_cbranch_execz Lw_t2_22
    s_waitcnt lgkmcnt(0)
    s_barrier
    ds_read_b128 v[128:131], v229 offset:0
    ds_read_b128 v[132:135], v229 offset:64
    ds_read_b128 v[136:139], v229 offset:128
    ds_read_b128 v[140:143], v229 offset:192
    s_waitcnt lgkmcnt(3)
    v_mfma_f32_16x16x32_bf16 v[64:67], v[96:99], v[128:131], 0
    v_mfma_f32_16x16x32_bf16 v[68:71], v[112:115], v[128:131], 0
Lw_t2_19:
    s_cbranch_execz Lw_t2_23
    s_waitcnt lgkmcnt(2)
    v_mfma_f32_16x16x32_bf16 v[64:67], v[100:103], v[132:135], v[64:67]
    v_mfma_f32_16x16x32_bf16 v[68:71], v[116:119], v[132:135], v[68:71]
    s_waitcnt lgkmcnt(1)
    v_mfma_f32_16x16x32_bf16 v[64:67], v[104:107], v[136:139], v[64:67]
    v_mfma_f32_16x16x32_bf16 v[68:71], v[120:123], v[136:139], v[68:71]
    s_waitcnt lgkmcnt(0)
    v_mfma_f32_16x16x32_bf16 v[64:67], v[108:111], v[140:143], v[64:67]
    v_mfma_f32_16x16x32_bf16 v[68:71], v[124:127], v[140:143], v[68:71]
    s_nop 6
    v_add_f32_dpp v64, v64, v64 quad_perm:[1,0,3,2] row_mask:0xf bank_mask:0xf
    v_add_f32_dpp v65, v65, v65 quad_perm:[1,0,3,2] row_mask:0xf bank_mask:0xf
    v_add_f32_dpp v66, v66, v66 quad_perm:[1,0,3,2] row_mask:0xf bank_mask:0xf
    v_add_f32_dpp v67, v67, v67 quad_perm:[1,0,3,2] row_mask:0xf bank_mask:0xf
    v_add_f32_dpp v68, v68, v68 quad_perm:[1,0,3,2] row_mask:0xf bank_mask:0xf
    v_add_f32_dpp v69, v69, v69 quad_perm:[1,0,3,2] row_mask:0xf bank_mask:0xf
    v_add_f32_dpp v70, v70, v70 quad_perm:[1,0,3,2] row_mask:0xf bank_mask:0xf
    v_add_f32_dpp v71, v71, v71 quad_perm:[1,0,3,2] row_mask:0xf bank_mask:0xf
Lw_t2_20:
    s_cbranch_execz Lw_t2_24
    s_mov_b32 exec_lo, 0x50005
    s_mov_b32 exec_hi, 0x50005
    v_cvt_pk_bf16_f32 v80, v64, v65
    v_cvt_pk_bf16_f32 v81, v66, v67
    v_cvt_pk_bf16_f32 v82, v68, v69
    v_cvt_pk_bf16_f32 v83, v70, v71
    v_min_u32 v80, -2, v80
    buffer_store_dwordx4 v[80:83], v230, s[4:7], s48 offen
    buffer_store_dwordx4 v[80:83], v230, s[4:7], s49 offen sc1
    s_mov_b64 exec, -1
    s_cmp_ge_u32 s43, 8
    s_cbranch_scc1 Lt_td
    s_mov_b32 s44, 39999
Lpoll_13:
    s_and_b32 s3, s44, 31
    s_cselect_b32 s3, s58, s59
    buffer_load_dwordx4 v[112:115], v36, s[4:7], s3 offen offset:0 sc1
    buffer_load_dwordx4 v[116:119], v36, s[4:7], s3 offen offset:1024 sc1
Lchk_15:
Lw_t2_21:
    s_cbranch_execz Lw_t2_25
    s_waitcnt vmcnt(0)
    v_max_u32 v38, v112, v116
    v_cmp_eq_u32 vcc, -1, v38
    s_cbranch_vccz Ldone_14
    s_sub_u32 s44, s44, 1
    s_cbranch_scc0 Lpoll_13
Ldone_14:
    v_mfma_f32_16x16x32_bf16 v[64:67], v[10:13], v[112:115], 0
    v_mfma_f32_16x16x32_bf16 v[64:67], v[14:17], v[116:119], v[64:67]
    s_nop 7
    v_cvt_pk_bf16_f32 v80, v64, v65
    v_cvt_pk_bf16_f32 v81, v66, v67
    ds_write_b64 v220, v[80:81]
Lw_t2_22:
    s_cbranch_execz Lw_t2_26
    s_waitcnt lgkmcnt(0)
    s_barrier
    ds_read_b128 v[144:147], v217 offset:0
    ds_read_b128 v[148:151], v217 offset:64
    ds_read_b128 v[152:155], v217 offset:128
    ds_read_b128 v[156:159], v217 offset:192
    ds_read_b128 v[160:163], v217 offset:256
    ds_read_b128 v[164:167], v217 offset:320
    ds_read_b128 v[168:171], v217 offset:384
    ds_read_b128 v[172:175], v217 offset:448
    ds_read_b128 v[176:179], v217 offset:512
    ds_read_b128 v[180:183], v217 offset:576
    ds_read_b128 v[184:187], v217 offset:640
    ds_read_b128 v[188:191], v217 offset:704
Lw_t2_23:
    s_cbranch_execz Lw_t2_27
    s_waitcnt lgkmcnt(11)
    s_nop 2
    v_mfma_f32_16x16x32_bf16 v[68:71], a[64:67], v[144:147], 0
    s_waitcnt lgkmcnt(10)
    v_mfma_f32_16x16x32_bf16 v[68:71], a[68:71], v[148:151], v[68:71]
    ds_read_b128 v[144:147], v217 offset:768
    s_waitcnt lgkmcnt(10)
    v_mfma_f32_16x16x32_bf16 v[68:71], a[72:75], v[152:155], v[68:71]
    ds_read_b128 v[148:151], v217 offset:832
    s_waitcnt lgkmcnt(10)
    v_mfma_f32_16x16x32_bf16 v[68:71], a[76:79], v[156:159], v[68:71]
    ds_read_b128 v[152:155], v217 offset:896
Lw_t2_24:
    s_cbranch_execz Lw_t2_28
    s_waitcnt lgkmcnt(10)
    v_mfma_f32_16x16x32_bf16 v[68:71], a[80:83], v[160:163], v[68:71]
    ds_read_b128 v[156:159], v217 offset:960
    s_waitcnt lgkmcnt(10)
    v_mfma_f32_16x16x32_bf16 v[68:71], a[84:87], v[164:167], v[68:71]
    s_waitcnt lgkmcnt(9)
    v_mfma_f32_16x16x32_bf16 v[68:71], a[88:91], v[168:171], v[68:71]
    s_waitcnt lgkmcnt(8)
    v_mfma_f32_16x16x32_bf16 v[68:71], a[92:95], v[172:175], v[68:71]
    s_waitcnt lgkmcnt(7)
Lw_t2_25:
    s_cbranch_execz Lw_t2_29
    v_mfma_f32_16x16x32_bf16 v[68:71], a[96:99], v[176:179], v[68:71]
    s_waitcnt lgkmcnt(6)
    v_mfma_f32_16x16x32_bf16 v[68:71], a[100:103], v[180:183], v[68:71]
    s_waitcnt lgkmcnt(5)
    v_mfma_f32_16x16x32_bf16 v[68:71], a[104:107], v[184:187], v[68:71]
    s_waitcnt lgkmcnt(4)
    v_mfma_f32_16x16x32_bf16 v[68:71], a[108:111], v[188:191], v[68:71]
    s_waitcnt lgkmcnt(3)
    v_mfma_f32_16x16x32_bf16 v[68:71], a[112:115], v[144:147], v[68:71]
    s_waitcnt lgkmcnt(2)
Lw_t2_26:
    s_cbranch_execz Lw_t2_30
    v_mfma_f32_16x16x32_bf16 v[68:71], a[116:119], v[148:151], v[68:71]
    s_waitcnt lgkmcnt(1)
    v_mfma_f32_16x16x32_bf16 v[68:71], a[120:123], v[152:155], v[68:71]
    s_waitcnt lgkmcnt(0)
    v_mfma_f32_16x16x32_bf16 v[68:71], a[124:127], v[156:159], v[68:71]
    s_nop 7
    v_cvt_pk_bf16_f32 v80, v68, v69
    v_cvt_pk_bf16_f32 v81, v70, v71
    s_nop 0
    v_mov_b32_dpp v82, v80 row_shl:1 row_mask:0xf bank_mask:0xf
    v_mov_b32_dpp v83, v81 row_shl:1 row_mask:0xf bank_mask:0xf
    s_mov_b32 exec_lo, 0x10001
    s_mov_b32 exec_hi, 0x10001
    v_min_u32 v80, -2, v80
    buffer_store_dwordx4 v[80:83], v223, s[4:7], s60 offen sc1
    s_endpgm
Lt_td:
    s_and_b32 s3, s42, 0x278
    s_cmp_eq_u32 s3, 0x78
    s_cbranch_scc1 Lrole_z
    s_endpgm
Lrole_z:
    v_lshlrev_b32 v34, 10, v209
    v_lshl_add_u32 v34, v214, 3, v34
Lw_t2_27:
    s_cbranch_execz Lw_t2_31
    v_lshlrev_b32 v35, 6, v209
    v_lshl_add_u32 v35, v214, 3, v35
    v_lshlrev_b32 v3, 11, v215
    v_lshl_add_u32 v3, v214, 4, v3
    s_bfe_u32 s3, s42, 0x30000
    s_lshl_b32 s45, s3, 7
    s_bfe_u32 s3, s42, 0x10008
    s_lshl_b32 s3, s3, 6
    s_add_u32 s45, s3, s45
    s_bfe_u32 s3, s42, 0x30000
    s_lshl_b32 s3, s3, 8
    s_add_u32 s46, s3, 40960
    s_bfe_u32 s3, s42, 0x10008
    s_lshl_b32 s3, s3, 7
    s_add_u32 s46, s3, s46
    s_bfe_u32 s3, s42, 0x30000
    s_mul_i32 s3, s3, 14336
    s_add_u32 s47, s3, 393216
    s_bfe_u32 s3, s42, 0x10008
    s_mul_i32 s3, s3, 7168
Lw_t2_28:
    s_cbranch_execz Lw_t2_32
    s_add_u32 s47, s3, s47
    s_add_u32 s52, s46, 6144
    s_add_u32 s53, s46, 8192
    s_add_u32 s51, s47, 4096
    v_and_b32 v232, 0x3f803f80, v232
    v_and_b32 v233, 0x3f803f80, v233
    v_and_b32 v234, 0x3f803f80, v234
    v_and_b32 v235, 0x3f803f80, v235
    buffer_load_dwordx2 v[26:27], v34, s[8:11], s45 offen
    s_mov_b32 s44, 39999
Lpoll_16:
    buffer_load_dwordx2 v[22:23], v35, s[4:7], s46 offen sc1
    buffer_load_dwordx2 v[24:25], v35, s[4:7], s52 offen sc1
Lchk_18:
Lw_t2_29:
    s_cbranch_execz Lw_t2_33
    s_waitcnt vmcnt(0)
    v_max_u32 v38, v22, v24
    v_cmp_eq_u32 vcc, -1, v38
    s_cbranch_vccz Ldone_17
    s_sub_u32 s44, s44, 1
    s_cbranch_scc0 Lpoll_16
Ldone_17:
    v_lshlrev_b32 v80, 16, v22
    v_and_b32 v81, 0xffff0000, v22
    v_lshlrev_b32 v82, 16, v23
    v_and_b32 v83, 0xffff0000, v23
    v_lshlrev_b32 v84, 16, v24
    v_and_b32 v85, 0xffff0000, v24
    v_lshlrev_b32 v86, 16, v25
    v_and_b32 v87, 0xffff0000, v25
    v_lshlrev_b32 v88, 16, v26
    v_and_b32 v89, 0xffff0000, v26
    v_lshlrev_b32 v90, 16, v27
    v_and_b32 v91, 0xffff0000, v27
    s_mov_b32 s44, 39999
Lpoll_19:
    buffer_load_dwordx4 v[22:25], v3, s[4:7], s53 offen sc1
Lchk_21:
Lw_t2_30:
    s_cbranch_execz Lw_t2_r
    s_waitcnt vmcnt(0)
    v_cmp_eq_u32 vcc, -1, v22
    s_cbranch_vccz Ldone_20
    s_sub_u32 s44, s44, 1
    s_cbranch_scc0 Lpoll_19
Ldone_20:
    v_mfma_f32_16x16x32_bf16 v[64:67], v[232:235], v[22:25], 0
    s_cmp_eq_u32 s45, 0
    s_cselect_b32 s3, 0, 2146435072
    s_mov_b64 exec, 1
    buffer_store_dword v62, v36, s[4:7], s3 offen sc1
    s_mov_b64 exec, -1
    s_nop 2
    v_add_f32_dpp v64, v64, v64 row_ror:8 row_mask:0xf bank_mask:0xf
    v_add_f32_dpp v65, v65, v65 row_ror:8 row_mask:0xf bank_mask:0xf
    v_add_f32_dpp v66, v66, v66 row_ror:8 row_mask:0xf bank_mask:0xf
    v_add_f32_dpp v67, v67, v67 row_ror:8 row_mask:0xf bank_mask:0xf
    v_pk_fma_f32 v[88:89], v[80:81], v[64:65], v[88:89]
    v_pk_fma_f32 v[90:91], v[82:83], v[66:67], v[90:91]
    s_mov_b32 s44, 39999
Lpoll_22:
    buffer_load_dwordx4 v[144:147], v36, s[4:7], s47 offen offset:0 sc1
    buffer_load_dwordx4 v[148:151], v36, s[4:7], s47 offen offset:1024 sc1
Lw_t2_31:
    s_cbranch_execz Lw_t2_r
    buffer_load_dwordx4 v[152:155], v36, s[4:7], s47 offen offset:2048 sc1
    buffer_load_dwordx4 v[156:159], v36, s[4:7], s47 offen offset:3072 sc1
    buffer_load_dwordx4 v[160:163], v36, s[4:7], s51 offen offset:0 sc1
    buffer_load_dwordx4 v[164:167], v36, s[4:7], s51 offen offset:1024 sc1
    buffer_load_dwordx4 v[168:171], v36, s[4:7], s51 offen offset:2048 sc1
Lchk_24:
    s_waitcnt vmcnt(0)
    v_max_u32 v38, v144, v146
    v_max3_u32 v38, v38, v148, v150
    v_max3_u32 v38, v38, v152, v154
    v_max3_u32 v38, v38, v156, v158
    v_max3_u32 v38, v38, v160, v162
    v_max3_u32 v38, v38, v164, v166
    v_max3_u32 v38, v38, v168, v170
    v_cmp_eq_u32 vcc, -1, v38
    s_cbranch_vccz Ldone_23
    s_sub_u32 s44, s44, 1
    s_cbranch_scc0 Lpoll_22
Ldone_23:
Lw_t2_32:
    s_cbranch_execz Lw_t2_r
    v_mfma_f32_16x16x32_bf16 v[64:67], v[232:235], v[144:147], 0
    v_mfma_f32_16x16x32_bf16 v[64:67], v[232:235], v[148:151], v[64:67]
    v_mfma_f32_16x16x32_bf16 v[64:67], v[232:235], v[152:155], v[64:67]
    v_mfma_f32_16x16x32_bf16 v[64:67], v[232:235], v[156:159], v[64:67]
    v_mfma_f32_16x16x32_bf16 v[64:67], v[232:235], v[160:163], v[64:67]
    v_mfma_f32_16x16x32_bf16 v[64:67], v[232:235], v[164:167], v[64:67]
    v_mfma_f32_16x16x32_bf16 v[64:67], v[232:235], v[168:171], v[64:67]
    s_nop 7
    v_add_f32_dpp v64, v64, v64 row_ror:8 row_mask:0xf bank_mask:0xf
    v_add_f32_dpp v65, v65, v65 row_ror:8 row_mask:0xf bank_mask:0xf
    v_add_f32_dpp v66, v66, v66 row_ror:8 row_mask:0xf bank_mask:0xf
    v_add_f32_dpp v67, v67, v67 row_ror:8 row_mask:0xf bank_mask:0xf
    v_pk_fma_f32 v[88:89], v[84:85], v[64:65], v[88:89]
    v_pk_fma_f32 v[90:91], v[86:87], v[66:67], v[90:91]
    v_cvt_pk_bf16_f32 v80, v88, v89
    v_cvt_pk_bf16_f32 v81, v90, v91
    s_mov_b64 exec, 0x00ff00ff
Lw_t2_33:
    s_cbranch_execz Lw_t2_r
    buffer_store_dwordx2 v[80:81], v34, s[36:39], s45 offen
    s_endpgm
Lrole_a:
    s_load_dwordx2 s[20:21], s[0:1], 8
    s_mov_b32 s22, 16777216
    s_mov_b32 s23, 0x20000
    s_cmp_ge_u32 s43, 8
    s_cbranch_scc1 La_m0
    v_bfe_u32 v195, v0, 0, 1
    v_lshlrev_b32 v194, 10, v195
    v_bfe_u32 v196, v0, 1, 1
    v_lshl_add_u32 v194, v196, 6, v194
    v_bfe_u32 v197, v0, 4, 2
    v_lshl_add_u32 v194, v197, 4, v194
    v_bfe_u32 v199, v0, 0, 6
    v_lshlrev_b32 v198, 5, v199
    v_lshlrev_b32 v200, 10, v195
    v_lshl_add_u32 v200, v197, 3, v200
    v_bfe_u32 v201, v0, 6, 2
    v_lshl_add_u32 v200, v201, 5, v200
    v_bfe_u32 v203, v0, 0, 3
    v_lshlrev_b32 v202, 4, v203
    v_bfe_u32 v204, v0, 3, 3
    s_mov_b32 s3, 6144
    v_mad_u32_u24 v202, v204, s3, v202
    s_bfe_u32 s3, s42, 0x30003
    s_lshl_b32 s35, s3, 7
    s_bfe_u32 s3, s42, 0x30000
    s_lshl_b32 s34, s3, 7
    s_bfe_u32 s3, s42, 0x20008
    s_lshl_b32 s3, s3, 12
    s_add_u32 m0, s3, 131072
    s_waitcnt lgkmcnt(0)
    buffer_load_dwordx4 v[128:131], v194, s[12:15], s35 offen
    buffer_load_dwordx4 v[132:135], v198, s[8:11], 0 offen
    buffer_load_dwordx4 v[136:139], v198, s[8:11], 0 offen offset:16
    buffer_load_dwordx2 v[140:141], v200, s[8:11], s34 offen
    s_bfe_u32 s3, s42, 0x30003
    s_mul_i32 s3, s3, 393216
    s_add_u32 s34, s3, s34
    s_bfe_u32 s3, s42, 0x20008
    s_mul_i32 s3, s3, 98304
    s_add_u32 s34, s3, s34
    buffer_load_dwordx4 v202, s[16:19], s34 offen offset:0 nt lds
    buffer_load_dwordx4 v202, s[16:19], s34 offen offset:1024 nt lds
    s_add_u32 s34, s34, 47104
    buffer_load_dwordx4 v202, s[16:19], s34 offen offset:2048 nt lds
    buffer_load_dwordx4 v202, s[16:19], s34 offen offset:3072 nt lds
    s_bfe_u32 s3, s42, 0x10002
    s_lshl_b32 s3, s3, 15
    s_add_u32 s35, s3, 65536
    s_bfe_u32 s3, s42, 0x20000
    s_lshl_b32 s3, s3, 13
    s_add_u32 s35, s3, s35
    s_bfe_u32 s3, s42, 0x30003
    s_lshl_b32 s3, s3, 10
    s_add_u32 s35, s3, s35
    s_bfe_u32 s3, s42, 0x20008
    s_lshl_b32 s3, s3, 8
    s_add_u32 s35, s3, s35
    s_xor_b32 s35, s35, 32768
    v_mov_b32 v154, -1
    v_lshrrev_b32 v155, 3, v198
    buffer_store_dword v154, v155, s[4:7], s35 offen sc1
La_m0:
    v_bfe_u32 v3, v0, 4, 2
    v_lshlrev_b32 v2, 1, v3
    v_bfe_u32 v4, v0, 0, 4
    v_xor_b32 v2, v2, v4
    v_lshlrev_b32 v6, 10, v3
    v_lshl_add_u32 v6, v2, 4, v6
    v_xor_b32 v7, 128, v6
    v_add_u32 v7, 3072, v7
    v_xor_b32 v8, 16, v6
    v_add_u32 v8, 6144, v8
    v_xor_b32 v9, 144, v6
    v_add_u32 v9, 9216, v9
    s_bfe_u32 s3, s42, 0x30000
    s_lshl_b32 s45, s3, 21
    s_bfe_u32 s3, s42, 0x40003
    s_lshl_b32 s3, s3, 17
    s_add_u32 s45, s3, s45
    s_bfe_u32 s3, s42, 0x20008
    s_lshl_b32 s3, s3, 15
    s_add_u32 s45, s3, s45
    s_bfe_u32 s3, s42, 0x20008
    s_lshl_b32 s46, s3, 13
    s_waitcnt lgkmcnt(0)
    s_load_dword s40, s[4:5], 0
    s_add_u32 m0, s46, 0
    s_add_u32 s47, s45, 0
    buffer_load_dwordx4 v6, s[20:23], s47 offen offset:0 nt lds
    buffer_load_dwordx4 v7, s[20:23], s47 offen offset:1024 nt lds
    buffer_load_dwordx4 v8, s[20:23], s47 offen offset:2048 nt lds
    buffer_load_dwordx4 v9, s[20:23], s47 offen offset:3072 nt lds
    s_add_u32 m0, s46, 4096
    s_add_u32 s47, s45, 16384
    buffer_load_dwordx4 v6, s[20:23], s47 offen offset:0 nt lds
    buffer_load_dwordx4 v7, s[20:23], s47 offen offset:1024 nt lds
    buffer_load_dwordx4 v8, s[20:23], s47 offen offset:2048 nt lds
    buffer_load_dwordx4 v9, s[20:23], s47 offen offset:3072 nt lds
    s_cmp_ge_u32 s43, 8
    s_cbranch_scc1 La_m1
    s_mov_b32 s3, 131072
    v_bfe_u32 v206, v0, 4, 2
    v_lshl_add_u32 v205, v206, 11, s3
    v_bfe_u32 v207, v0, 2, 2
    v_lshl_add_u32 v205, v207, 7, v205
    v_bfe_u32 v208, v0, 6, 2
    v_lshl_add_u32 v205, v208, 5, v205
    v_bfe_u32 v209, v0, 0, 2
    v_lshl_add_u32 v205, v209, 3, v205
    v_lshlrev_b32 v210, 5, v206
    v_bfe_u32 v211, v0, 0, 1
    v_lshl_add_u32 v210, v211, 4, v210
    s_bfe_u32 s3, s42, 0x20001
    s_lshl_b32 s3, s3, 13
    s_add_u32 s34, s3, 8192
    s_bfe_u32 s3, s42, 0x10000
    s_lshl_b32 s3, s3, 12
    s_add_u32 s34, s3, s34
    s_bfe_u32 s3, s42, 0x10009
    s_lshl_b32 s3, s3, 11
    s_add_u32 s34, s3, s34
    s_bfe_u32 s3, s42, 0x30003
    s_lshl_b32 s3, s3, 8
    s_add_u32 s34, s3, s34
    s_bfe_u32 s3, s42, 0x10008
    s_lshl_b32 s3, s3, 7
    s_add_u32 s34, s3, s34
    s_waitcnt vmcnt(16)
    v_lshlrev_b32 v154, 16, v128
    v_and_b32 v155, 0xffff0000, v128
    v_lshlrev_b32 v156, 16, v129
    v_and_b32 v157, 0xffff0000, v129
    v_lshlrev_b32 v158, 16, v130
    v_and_b32 v159, 0xffff0000, v130
    v_lshlrev_b32 v160, 16, v131
    v_and_b32 v161, 0xffff0000, v131
    v_mul_f32 v162, 0xbfb8aa3b, v154
    v_mul_f32 v163, 0xbfb8aa3b, v155
    v_mul_f32 v164, 0xbfb8aa3b, v156
    v_mul_f32 v165, 0xbfb8aa3b, v157
    v_mul_f32 v166, 0xbfb8aa3b, v158
    v_mul_f32 v167, 0xbfb8aa3b, v159
    v_mul_f32 v168, 0xbfb8aa3b, v160
    v_mul_f32 v169, 0xbfb8aa3b, v161
    v_exp_f32 v162, v162
    v_exp_f32 v163, v163
    v_exp_f32 v164, v164
    v_exp_f32 v165, v165
    v_exp_f32 v166, v166
    v_exp_f32 v167, v167
    v_exp_f32 v168, v168
    v_exp_f32 v169, v169
    v_add_f32 v162, 1.0, v162
    v_add_f32 v163, 1.0, v163
    v_add_f32 v164, 1.0, v164
    v_add_f32 v165, 1.0, v165
    v_add_f32 v166, 1.0, v166
    v_add_f32 v167, 1.0, v167
    v_add_f32 v168, 1.0, v168
    v_add_f32 v169, 1.0, v169
    v_rcp_f32 v162, v162
    v_rcp_f32 v163, v163
    v_rcp_f32 v164, v164
    v_rcp_f32 v165, v165
    v_rcp_f32 v166, v166
    v_rcp_f32 v167, v167
    v_rcp_f32 v168, v168
    v_rcp_f32 v169, v169
    v_pk_mul_f32 v[154:155], v[154:155], v[162:163]
    v_pk_mul_f32 v[156:157], v[156:157], v[164:165]
    v_pk_mul_f32 v[158:159], v[158:159], v[166:167]
    v_pk_mul_f32 v[160:161], v[160:161], v[168:169]
    v_cvt_pk_bf16_f32 v162, v154, v155
    v_cvt_pk_bf16_f32 v163, v156, v157
    v_cvt_pk_bf16_f32 v164, v158, v159
    v_cvt_pk_bf16_f32 v165, v160, v161
    v_mov_b32_dpp v186, v162 quad_perm:[0,1,0,1] row_mask:0xf bank_mask:0xf
    v_mov_b32_dpp v187, v163 quad_perm:[0,1,0,1] row_mask:0xf bank_mask:0xf
    v_mov_b32_dpp v188, v164 quad_perm:[0,1,0,1] row_mask:0xf bank_mask:0xf
    v_mov_b32_dpp v189, v165 quad_perm:[0,1,0,1] row_mask:0xf bank_mask:0xf
    v_mov_b32_dpp v190, v162 quad_perm:[2,3,2,3] row_mask:0xf bank_mask:0xf
    v_mov_b32_dpp v191, v163 quad_perm:[2,3,2,3] row_mask:0xf bank_mask:0xf
    v_mov_b32_dpp v192, v164 quad_perm:[2,3,2,3] row_mask:0xf bank_mask:0xf
    v_mov_b32_dpp v193, v165 quad_perm:[2,3,2,3] row_mask:0xf bank_mask:0xf
    s_cmp_eq_u32 s43, 0
    s_cselect_b32 s3, 1.0, 0
    v_mov_b32 v150, s3
    v_mov_b32 v151, s3
    v_mov_b32 v152, s3
    v_mov_b32 v153, s3
    s_waitcnt lgkmcnt(0)
    s_add_u32 s3, s40, 0x9e3779b9
    v_mov_b32 v144, s3
    v_mov_b32 v145, s3
    s_waitcnt vmcnt(13)
    v_lshlrev_b32 v154, 16, v132
    v_and_b32 v155, 0xffff0000, v132
    v_lshlrev_b32 v156, 16, v133
    v_and_b32 v157, 0xffff0000, v133
    v_pk_mul_f32 v[160:161], v[154:155], v[154:155]
    v_pk_add_f32 v[158:159], v[154:155], v[156:157]
    v_pk_fma_f32 v[160:161], v[156:157], v[156:157], v[160:161]
    v_lshlrev_b32 v154, 16, v134
    v_and_b32 v155, 0xffff0000, v134
    v_lshlrev_b32 v156, 16, v135
    v_and_b32 v157, 0xffff0000, v135
    v_pk_add_f32 v[158:159], v[158:159], v[154:155]
    v_pk_fma_f32 v[160:161], v[154:155], v[154:155], v[160:161]
    v_pk_add_f32 v[158:159], v[158:159], v[156:157]
    v_pk_fma_f32 v[160:161], v[156:157], v[156:157], v[160:161]
    v_lshlrev_b32 v154, 16, v136
    v_and_b32 v155, 0xffff0000, v136
    v_lshlrev_b32 v156, 16, v137
    v_and_b32 v157, 0xffff0000, v137
    v_pk_add_f32 v[158:159], v[158:159], v[154:155]
    v_pk_fma_f32 v[160:161], v[154:155], v[154:155], v[160:161]
    v_pk_add_f32 v[158:159], v[158:159], v[156:157]
    v_pk_fma_f32 v[160:161], v[156:157], v[156:157], v[160:161]
    v_lshlrev_b32 v154, 16, v138
    v_and_b32 v155, 0xffff0000, v138
    v_lshlrev_b32 v156, 16, v139
    v_and_b32 v157, 0xffff0000, v139
    v_pk_add_f32 v[158:159], v[158:159], v[154:155]
    v_pk_fma_f32 v[160:161], v[154:155], v[154:155], v[160:161]
    v_pk_add_f32 v[158:159], v[158:159], v[156:157]
    v_pk_fma_f32 v[160:161], v[156:157], v[156:157], v[160:161]
    v_add_f32 v158, v158, v159
    v_add_f32 v160, v160, v161
    s_nop 0
    v_add_f32_dpp v158, v158, v158 quad_perm:[1,0,3,2] row_mask:0xf bank_mask:0xf
    v_add_f32_dpp v160, v160, v160 quad_perm:[1,0,3,2] row_mask:0xf bank_mask:0xf
    s_nop 0
    v_add_f32_dpp v158, v158, v158 quad_perm:[2,3,0,1] row_mask:0xf bank_mask:0xf
    v_add_f32_dpp v160, v160, v160 quad_perm:[2,3,0,1] row_mask:0xf bank_mask:0xf
    s_nop 0
    v_add_f32_dpp v158, v158, v158 row_half_mirror row_mask:0xf bank_mask:0xf
    v_add_f32_dpp v160, v160, v160 row_half_mirror row_mask:0xf bank_mask:0xf
    s_nop 0
    v_add_f32_dpp v158, v158, v158 row_mirror row_mask:0xf bank_mask:0xf
    v_add_f32_dpp v160, v160, v160 row_mirror row_mask:0xf bank_mask:0xf
    v_mov_b32 v154, v158
    v_mov_b32 v155, v160
    s_nop 0
    v_permlane16_swap_b32 v154, v158
    v_permlane16_swap_b32 v155, v160
    v_add_f32 v158, v158, v154
    v_add_f32 v160, v160, v155
    v_mul_f32 v158, 0x3b000000, v158
    v_mul_f32 v160, 0x3b000000, v160
    v_fma_f32 v160, -v158, v158, v160
    v_max_f32 v160, 0, v160
    v_add_f32 v160, 0x3727c5ac, v160
    v_rsq_f32 v160, v160
    v_mov_b32 v154, v158
    v_cmp_eq_u32 vcc, 1, v211
    v_mov_b32 v155, v160
    v_permlane32_swap_b32 v158, v154
    s_nop 0
    v_permlane32_swap_b32 v160, v155
    v_cndmask_b32 v158, v158, v154, vcc
    v_cndmask_b32 v160, v160, v155, vcc
    v_lshlrev_b32 v162, 16, v140
    v_and_b32 v163, 0xffff0000, v140
    v_lshlrev_b32 v164, 16, v141
    v_and_b32 v165, 0xffff0000, v141
    v_sub_f32 v162, v162, v158
    v_sub_f32 v163, v163, v158
    v_sub_f32 v164, v164, v158
    v_sub_f32 v165, v165, v158
    v_mul_f32 v162, v162, v160
    v_mul_f32 v163, v163, v160
    v_mul_f32 v164, v164, v160
    v_mul_f32 v165, v165, v160
    s_waitcnt vmcnt(8)
    s_barrier
    ds_read_b64_tr_b16 v[170:171], v205 offset:0
    ds_read_b64_tr_b16 v[172:173], v205 offset:512
    ds_read_b64_tr_b16 v[174:175], v205 offset:1024
    ds_read_b64_tr_b16 v[176:177], v205 offset:1536
    ds_read_b64_tr_b16 v[178:179], v205 offset:8192
    ds_read_b64_tr_b16 v[180:181], v205 offset:8704
    ds_read_b64_tr_b16 v[182:183], v205 offset:9216
    ds_read_b64_tr_b16 v[184:185], v205 offset:9728
    s_waitcnt lgkmcnt(6)
    v_mfma_f32_16x16x32_bf16 v[146:149], v[170:173], v[186:189], 0
    s_waitcnt lgkmcnt(4)
    v_mfma_f32_16x16x32_bf16 v[150:153], v[174:177], v[186:189], v[150:153]
    s_waitcnt lgkmcnt(2)
    v_mfma_f32_16x16x32_bf16 v[146:149], v[178:181], v[190:193], v[146:149]
    s_waitcnt lgkmcnt(0)
    v_mfma_f32_16x16x32_bf16 v[150:153], v[182:185], v[190:193], v[150:153]
    s_mov_b32 exec_lo, 0x30003
    s_mov_b32 exec_hi, 0x30003
    s_nop 5
    v_pk_fma_f32 v[146:147], v[162:163], v[150:151], v[146:147]
    v_pk_fma_f32 v[148:149], v[164:165], v[152:153], v[148:149]
    v_cvt_pk_bf16_f32 v142, v146, v147
    v_cvt_pk_bf16_f32 v143, v148, v149
    buffer_store_dwordx4 v[142:145], v210, s[4:7], s34 offen sc1
    s_mov_b64 exec, -1
La_m1:
    v_lshlrev_b32 v14, 19, v3
    v_lshl_add_u32 v14, v4, 4, v14
    s_bfe_u32 s3, s42, 0x20008
    s_lshl_b32 s3, s3, 15
    s_add_u32 s48, s3, 1048576
    s_bfe_u32 s3, s42, 0x30000
    s_lshl_b32 s3, s3, 12
    s_add_u32 s48, s3, s48
    s_bfe_u32 s3, s42, 0x40003
    s_lshl_b32 s3, s3, 8
    s_add_u32 s48, s3, s48
    s_add_u32 s49, s48, 131072
    s_add_u32 s50, s48, 262144
    s_add_u32 s51, s48, 393216
    s_add_u32 s52, s48, 2097152
    s_add_u32 s53, s48, 2228224
    s_add_u32 s54, s48, 2359296
    s_add_u32 s55, s48, 2490368
    v_bfe_u32 v16, v0, 1, 1
    v_lshlrev_b32 v15, 6, v16
    v_lshl_add_u32 v15, v3, 4, v15
    v_bfe_u32 v17, v0, 0, 1
    v_lshl_add_u32 v15, v17, 3, v15
    v_bfe_u32 v18, v0, 2, 2
    s_mov_b32 s3, 7168
    v_mad_u32_u24 v15, v18, s3, v15
    s_bfe_u32 s3, s42, 0x20008
    s_mul_i32 s3, s3, 28672
    s_add_u32 s56, s3, 393216
    s_bfe_u32 s3, s42, 0x30000
    s_mul_i32 s3, s3, 896
    s_add_u32 s56, s3, s56
    s_bfe_u32 s3, s42, 0x30003
    s_lshl_b32 s3, s3, 7
    s_add_u32 s56, s3, s56
    s_sub_u32 s3, s43, 8
    s_cmp_lt_u32 s3, 7
    s_cselect_b32 s56, s56, 2146435072
    v_mov_b64 v[10:11], -1
    v_mov_b64 v[12:13], -1
    v_bfe_u32 v40, v0, 0, 3
    v_lshlrev_b32 v2, 1, v40
    v_bfe_u32 v41, v0, 3, 1
    v_lshl_add_u32 v2, v41, 0, v2
    v_bfe_u32 v42, v0, 5, 1
    v_xor_b32 v2, v2, v42
    v_lshlrev_b32 v2, 4, v2
    v_bfe_u32 v43, v0, 0, 5
    v_lshl_add_u32 v2, v43, 8, v2
    v_xor_b32 v44, 0, v2
    v_add_u32 v20, s46, v44
    v_add_u32 v28, 131072, v44
    v_xor_b32 v44, 32, v2
    v_add_u32 v21, s46, v44
    v_add_u32 v29, 131072, v44
    v_xor_b32 v44, 64, v2
    v_add_u32 v22, s46, v44
    v_add_u32 v30, 131072, v44
    v_xor_b32 v44, 96, v2
    v_add_u32 v23, s46, v44
    v_add_u32 v31, 131072, v44
    v_xor_b32 v44, 128, v2
    v_add_u32 v24, s46, v44
    v_add_u32 v32, 131072, v44
    v_xor_b32 v44, 160, v2
    v_add_u32 v25, s46, v44
    v_add_u32 v33, 131072, v44
    v_xor_b32 v44, 192, v2
    v_add_u32 v26, s46, v44
    v_add_u32 v34, 131072, v44
    v_xor_b32 v44, 224, v2
    v_add_u32 v27, s46, v44
    v_add_u32 v35, 131072, v44
    v_bfe_u32 v45, v0, 6, 2
    v_lshlrev_b32 v2, 2, v45
    v_lshl_add_u32 v2, v16, 0, v2
    v_bfe_u32 v46, v0, 4, 1
    v_lshlrev_b32 v44, 3, v46
    v_lshl_add_u32 v44, v18, 1, v44
    v_xor_b32 v2, v2, v44
    v_lshlrev_b32 v36, 12, v42
    v_lshl_add_u32 v36, v46, 10, v36
    v_lshl_add_u32 v36, v18, 8, v36
    v_lshl_add_u32 v36, v2, 4, v36
    v_lshl_add_u32 v36, v17, 3, v36
    v_xor_b32 v37, 2064, v36
    v_xor_b32 v38, 32, v36
    v_xor_b32 v39, 2096, v36
    v_bfe_u32 v48, v0, 0, 6
    v_lshlrev_b32 v47, 4, v48
    s_mov_b32 s3, 65536
    v_lshl_add_u32 v49, v47, 0, s3
    v_lshl_add_u32 v49, v45, 11, v49
    s_mov_b32 s3, 65536
    v_lshl_add_u32 v50, v3, 9, s3
    v_lshl_add_u32 v50, v4, 4, v50
    s_mov_b32 s3, 73728
    v_lshl_add_u32 v51, v47, 0, s3
    v_lshl_add_u32 v51, v45, 2, v51
    s_mov_b32 s3, 73728
    v_lshl_add_u32 v52, v43, 4, s3
    s_bfe_u32 s3, s42, 0x10002
    s_lshl_b32 s3, s3, 15
    s_add_u32 s57, s3, 65536
    s_bfe_u32 s3, s42, 0x20008
    s_lshl_b32 s3, s3, 13
    s_add_u32 s57, s3, s57
    s_bfe_u32 s3, s42, 0x30000
    s_lshl_b32 s3, s3, 7
    s_add_u32 s58, s3, 4096
    s_add_u32 s16, s58, 2048
    s_mov_b32 s3, 131072
    v_lshl_add_u32 v53, v47, 0, s3
    v_lshl_add_u32 v53, v45, 13, v53
    s_bfe_u32 s3, s42, 0x30000
    s_lshl_b32 s3, s3, 13
    s_add_u32 s59, s3, 262144
    s_bfe_u32 s3, s42, 0x40003
    s_lshl_b32 s3, s3, 9
    s_add_u32 s59, s3, s59
    s_cmp_eq_u32 s41, 0
    s_cselect_b32 s59, s59, 2146435072
    s_mov_b32 s32, 0x3e0293ee
    s_load_dwordx2 s[24:25], s[0:1], 56
    s_load_dwordx2 s[28:29], s[0:1], 64
    s_mov_b32 s26, 1835008
    s_mov_b32 s27, 0x20000
    s_mov_b32 s30, 1835008
    s_mov_b32 s31, 0x20000
    v_lshlrev_b32 v2, 1, v42
    v_bfe_u32 v56, v0, 0, 2
    v_xor_b32 v2, v2, v56
    v_lshlrev_b32 v54, 4, v2
    v_bfe_u32 v57, v0, 2, 4
    s_mov_b32 s3, 3584
    v_mad_u32_u24 v54, v57, s3, v54
    v_lshlrev_b32 v2, 2, v3
    v_xor_b32 v2, v2, v4
    v_lshlrev_b32 v55, 4, v2
    v_lshl_add_u32 v55, v3, 10, v55
    s_bfe_u32 s3, s42, 0x20008
    s_mul_i32 s12, s3, 458752
    s_bfe_u32 s3, s42, 0x30000
    s_mul_i32 s3, s3, 448
    s_add_u32 s12, s3, s12
    s_bfe_u32 s3, s42, 0x30003
    s_lshl_b32 s3, s3, 6
    s_add_u32 s12, s3, s12
    s_bfe_u32 s3, s42, 0x30000
    s_mul_i32 s13, s3, 229376
    s_bfe_u32 s3, s42, 0x30003
    s_lshl_b32 s3, s3, 15
    s_add_u32 s13, s3, s13
    s_bfe_u32 s3, s42, 0x20008
    s_lshl_b32 s3, s3, 8
    s_add_u32 s13, s3, s13
    s_mov_b32 s14, 57344
    s_movk_i32 s15, 4096
    s_add_u32 m0, s46, 32768
    s_add_u32 s47, s45, 256
    buffer_load_dwordx4 v6, s[20:23], s47 offen offset:0 nt lds
    buffer_load_dwordx4 v7, s[20:23], s47 offen offset:1024 nt lds
    buffer_load_dwordx4 v8, s[20:23], s47 offen offset:2048 nt lds
    buffer_load_dwordx4 v9, s[20:23], s47 offen offset:3072 nt lds
    s_add_u32 m0, s46, 36864
    s_add_u32 s47, s45, 16640
    buffer_load_dwordx4 v6, s[20:23], s47 offen offset:0 nt lds
    buffer_load_dwordx4 v7, s[20:23], s47 offen offset:1024 nt lds
    buffer_load_dwordx4 v8, s[20:23], s47 offen offset:2048 nt lds
    buffer_load_dwordx4 v9, s[20:23], s47 offen offset:3072 nt lds
    s_waitcnt lgkmcnt(0)
    s_add_u32 s40, s40, 0x9e3779b9
    v_mov_b32 v60, s40
    v_mov_b32 v61, s40
    s_waitcnt vmcnt(8)
    s_barrier
    s_add_u32 m0, s46, 65536
    s_add_u32 s47, s45, 512
    buffer_load_dwordx4 v6, s[20:23], s47 offen offset:0 nt lds
    buffer_load_dwordx4 v7, s[20:23], s47 offen offset:1024 nt lds
    buffer_load_dwordx4 v8, s[20:23], s47 offen offset:2048 nt lds
    buffer_load_dwordx4 v9, s[20:23], s47 offen offset:3072 nt lds
    s_add_u32 m0, s46, 69632
    s_add_u32 s47, s45, 16896
    buffer_load_dwordx4 v6, s[20:23], s47 offen offset:0 nt lds
    buffer_load_dwordx4 v7, s[20:23], s47 offen offset:1024 nt lds
    buffer_load_dwordx4 v8, s[20:23], s47 offen offset:2048 nt lds
    buffer_load_dwordx4 v9, s[20:23], s47 offen offset:3072 nt lds
    ds_read_b128 a[0:3], v20 offset:0
    ds_read_b128 a[4:7], v21 offset:0
    ds_read_b128 a[8:11], v22 offset:0
    ds_read_b128 a[12:15], v23 offset:0
    ds_read_b128 a[16:19], v24 offset:0
    ds_read_b128 a[20:23], v25 offset:0
    ds_read_b128 a[24:27], v26 offset:0
    ds_read_b128 a[28:31], v27 offset:0
    ds_read_b64_tr_b16 a[128:129], v36 offset:0
    ds_read_b64_tr_b16 a[130:131], v37 offset:0
    ds_read_b64_tr_b16 a[132:133], v36 offset:8192
    ds_read_b64_tr_b16 a[134:135], v37 offset:8192
    ds_read_b64_tr_b16 a[136:137], v36 offset:16384
    ds_read_b64_tr_b16 a[138:139], v37 offset:16384
    ds_read_b64_tr_b16 a[140:141], v36 offset:24576
    s_waitcnt lgkmcnt(7)
    ds_read_b64_tr_b16 a[142:143], v37 offset:24576
    ds_read_b64_tr_b16 a[144:145], v38 offset:0
    ds_read_b64_tr_b16 a[146:147], v39 offset:0
    ds_read_b64_tr_b16 a[148:149], v38 offset:8192
    ds_read_b64_tr_b16 a[150:151], v39 offset:8192
    ds_read_b64_tr_b16 a[152:153], v38 offset:16384
    ds_read_b64_tr_b16 a[154:155], v39 offset:16384
    ds_read_b64_tr_b16 a[156:157], v38 offset:24576
    s_waitcnt lgkmcnt(7)
    ds_read_b64_tr_b16 a[158:159], v39 offset:24576
    s_waitcnt lgkmcnt(0)
    s_waitcnt vmcnt(8)
    s_barrier
    s_add_u32 m0, s46, 98304
    s_add_u32 s47, s45, 768
    buffer_load_dwordx4 v6, s[20:23], s47 offen offset:0 nt lds
    buffer_load_dwordx4 v7, s[20:23], s47 offen offset:1024 nt lds
    buffer_load_dwordx4 v8, s[20:23], s47 offen offset:2048 nt lds
    buffer_load_dwordx4 v9, s[20:23], s47 offen offset:3072 nt lds
    s_add_u32 m0, s46, 102400
    s_add_u32 s47, s45, 17152
    buffer_load_dwordx4 v6, s[20:23], s47 offen offset:0 nt lds
    buffer_load_dwordx4 v7, s[20:23], s47 offen offset:1024 nt lds
    buffer_load_dwordx4 v8, s[20:23], s47 offen offset:2048 nt lds
    buffer_load_dwordx4 v9, s[20:23], s47 offen offset:3072 nt lds
    ds_read_b128 a[32:35], v20 offset:32768
    ds_read_b128 a[36:39], v21 offset:32768
    ds_read_b128 a[40:43], v22 offset:32768
    ds_read_b128 a[44:47], v23 offset:32768
    ds_read_b128 a[48:51], v24 offset:32768
    ds_read_b128 a[52:55], v25 offset:32768
    ds_read_b128 a[56:59], v26 offset:32768
    ds_read_b128 a[60:63], v27 offset:32768
    ds_read_b64_tr_b16 a[160:161], v36 offset:32768
    ds_read_b64_tr_b16 a[162:163], v37 offset:32768
    ds_read_b64_tr_b16 a[164:165], v36 offset:40960
    ds_read_b64_tr_b16 a[166:167], v37 offset:40960
    ds_read_b64_tr_b16 a[168:169], v36 offset:49152
    ds_read_b64_tr_b16 a[170:171], v37 offset:49152
    ds_read_b64_tr_b16 a[172:173], v36 offset:57344
    s_waitcnt lgkmcnt(7)
    ds_read_b64_tr_b16 a[174:175], v37 offset:57344
    ds_read_b64_tr_b16 a[176:177], v38 offset:32768
    ds_read_b64_tr_b16 a[178:179], v39 offset:32768
    ds_read_b64_tr_b16 a[180:181], v38 offset:40960
    ds_read_b64_tr_b16 a[182:183], v39 offset:40960
    ds_read_b64_tr_b16 a[184:185], v38 offset:49152
    ds_read_b64_tr_b16 a[186:187], v39 offset:49152
    ds_read_b64_tr_b16 a[188:189], v38 offset:57344
    s_waitcnt lgkmcnt(7)
    ds_read_b64_tr_b16 a[190:191], v39 offset:57344
    s_waitcnt lgkmcnt(0)
    v_add_u32 v20, 0x10000, v20
    v_add_u32 v21, 0x10000, v21
    v_add_u32 v22, 0x10000, v22
    v_add_u32 v23, 0x10000, v23
    v_add_u32 v24, 0x10000, v24
    v_add_u32 v25, 0x10000, v25
    v_add_u32 v26, 0x10000, v26
    v_add_u32 v27, 0x10000, v27
    v_add_u32 v36, 0x10000, v36
    v_add_u32 v37, 0x10000, v37
    v_add_u32 v38, 0x10000, v38
    v_add_u32 v39, 0x10000, v39
    s_waitcnt vmcnt(8)
    s_barrier
    ds_read_b128 a[64:67], v20 offset:0
    ds_read_b128 a[68:71], v21 offset:0
    ds_read_b128 a[72:75], v22 offset:0
    ds_read_b128 a[76:79], v23 offset:0
    ds_read_b128 a[80:83], v24 offset:0
    ds_read_b128 a[84:87], v25 offset:0
    ds_read_b128 a[88:91], v26 offset:0
    ds_read_b128 a[92:95], v27 offset:0
    ds_read_b64_tr_b16 a[192:193], v36 offset:0
    ds_read_b64_tr_b16 a[194:195], v37 offset:0
    ds_read_b64_tr_b16 a[196:197], v36 offset:8192
    ds_read_b64_tr_b16 a[198:199], v37 offset:8192
    ds_read_b64_tr_b16 a[200:201], v36 offset:16384
    ds_read_b64_tr_b16 a[202:203], v37 offset:16384
    ds_read_b64_tr_b16 a[204:205], v36 offset:24576
    s_waitcnt lgkmcnt(7)
    ds_read_b64_tr_b16 a[206:207], v37 offset:24576
    ds_read_b64_tr_b16 a[208:209], v38 offset:0
    ds_read_b64_tr_b16 a[210:211], v39 offset:0
    ds_read_b64_tr_b16 a[212:213], v38 offset:8192
    ds_read_b64_tr_b16 a[214:215], v39 offset:8192
    ds_read_b64_tr_b16 a[216:217], v38 offset:16384
    ds_read_b64_tr_b16 a[218:219], v39 offset:16384
    ds_read_b64_tr_b16 a[220:221], v38 offset:24576
    s_waitcnt lgkmcnt(7)
    ds_read_b64_tr_b16 a[222:223], v39 offset:24576
    s_waitcnt lgkmcnt(0)
    s_add_u32 s47, s57, 4096
    s_waitcnt vmcnt(0)
    s_barrier
    s_mov_b32 s44, 39999
    buffer_load_dwordx4 v[62:65], off, s[4:7], s58 sc1
    ds_read_b128 a[96:99], v20 offset:32768
    ds_read_b128 a[100:103], v21 offset:32768
    ds_read_b128 a[104:107], v22 offset:32768
    ds_read_b128 a[108:111], v23 offset:32768
    ds_read_b128 a[112:115], v24 offset:32768
    ds_read_b128 a[116:119], v25 offset:32768
    ds_read_b128 a[120:123], v26 offset:32768
    ds_read_b128 a[124:127], v27 offset:32768
    ds_read_b64_tr_b16 a[224:225], v36 offset:32768
    ds_read_b64_tr_b16 a[226:227], v37 offset:32768
    ds_read_b64_tr_b16 a[228:229], v36 offset:40960
    ds_read_b64_tr_b16 a[230:231], v37 offset:40960
    ds_read_b64_tr_b16 a[232:233], v36 offset:49152
    ds_read_b64_tr_b16 a[234:235], v37 offset:49152
    ds_read_b64_tr_b16 a[236:237], v36 offset:57344
    s_waitcnt lgkmcnt(7)
    ds_read_b64_tr_b16 a[238:239], v37 offset:57344
    ds_read_b64_tr_b16 a[240:241], v38 offset:32768
    ds_read_b64_tr_b16 a[242:243], v39 offset:32768
    ds_read_b64_tr_b16 a[244:245], v38 offset:40960
    ds_read_b64_tr_b16 a[246:247], v39 offset:40960
    ds_read_b64_tr_b16 a[248:249], v38 offset:49152
    ds_read_b64_tr_b16 a[250:251], v39 offset:49152
    ds_read_b64_tr_b16 a[252:253], v38 offset:57344
    s_waitcnt lgkmcnt(7)
    ds_read_b64_tr_b16 a[254:255], v39 offset:57344
    s_waitcnt lgkmcnt(0)
    s_branch Lchk_27
Lpoll_25:
    s_and_b32 s3, s44, 31
    s_cselect_b32 s3, s58, s16
    buffer_load_dwordx4 v[62:65], off, s[4:7], s3 sc1
Lchk_27:
    s_waitcnt vmcnt(0)
    v_xor_b32 v2, s40, v62
    v_bitop3_b32 v2, v63, s40, v2 bitop3:0xbe
    v_bitop3_b32 v2, v64, s40, v2 bitop3:0xbe
    v_bitop3_b32 v2, v65, s40, v2 bitop3:0xbe
    v_cmp_ne_u32 vcc, 0, v2
    s_cbranch_vccz Ldone_26
    s_sub_u32 s44, s44, 1
    s_cbranch_scc0 Lpoll_25
Ldone_26:
    s_mov_b32 s44, 39999
    buffer_load_dwordx4 v[62:65], v47, s[4:7], s57 offen offset:0
    buffer_load_dwordx4 v[66:69], v47, s[4:7], s57 offen offset:1024
    buffer_load_dwordx4 v[70:73], v47, s[4:7], s57 offen offset:2048
    buffer_load_dwordx4 v[74:77], v47, s[4:7], s57 offen offset:3072
    buffer_load_dwordx4 v[78:81], v47, s[4:7], s47 offen offset:0
    buffer_load_dwordx4 v[82:85], v47, s[4:7], s47 offen offset:1024
    buffer_load_dwordx4 v[86:89], v47, s[4:7], s47 offen offset:2048
    buffer_load_dwordx4 v[90:93], v47, s[4:7], s47 offen offset:3072
Lchk_29:
    s_waitcnt vmcnt(0)
    v_max_u32 v2, v62, v66
    v_max3_u32 v2, v2, v70, v74
    v_max3_u32 v2, v2, v78, v82
    v_max3_u32 v2, v2, v86, v90
    v_cmp_eq_u32 vcc, -1, v2
    s_cbranch_vccz Ldone_28
    v_cmp_eq_u32 vcc, -1, v62
    s_mov_b64 exec, vcc
    buffer_load_dwordx4 v[62:65], v47, s[4:7], s57 offen offset:0 sc1
    s_mov_b64 exec, -1
    v_cmp_eq_u32 vcc, -1, v66
    s_mov_b64 exec, vcc
    buffer_load_dwordx4 v[66:69], v47, s[4:7], s57 offen offset:1024 sc1
    s_mov_b64 exec, -1
    v_cmp_eq_u32 vcc, -1, v70
    s_mov_b64 exec, vcc
    buffer_load_dwordx4 v[70:73], v47, s[4:7], s57 offen offset:2048 sc1
    s_mov_b64 exec, -1
    v_cmp_eq_u32 vcc, -1, v74
    s_mov_b64 exec, vcc
    buffer_load_dwordx4 v[74:77], v47, s[4:7], s57 offen offset:3072 sc1
    s_mov_b64 exec, -1
    v_cmp_eq_u32 vcc, -1, v78
    s_mov_b64 exec, vcc
    buffer_load_dwordx4 v[78:81], v47, s[4:7], s47 offen offset:0 sc1
    s_mov_b64 exec, -1
    v_cmp_eq_u32 vcc, -1, v82
    s_mov_b64 exec, vcc
    buffer_load_dwordx4 v[82:85], v47, s[4:7], s47 offen offset:1024 sc1
    s_mov_b64 exec, -1
    v_cmp_eq_u32 vcc, -1, v86
    s_mov_b64 exec, vcc
    buffer_load_dwordx4 v[86:89], v47, s[4:7], s47 offen offset:2048 sc1
    s_mov_b64 exec, -1
    v_cmp_eq_u32 vcc, -1, v90
    s_mov_b64 exec, vcc
    buffer_load_dwordx4 v[90:93], v47, s[4:7], s47 offen offset:3072 sc1
    s_mov_b64 exec, -1
    s_sub_u32 s44, s44, 1
    s_cbranch_scc0 Lchk_29
Ldone_28:
    ds_write_b128 v53, v[62:65] offset:0
    ds_write_b128 v53, v[66:69] offset:1024
    ds_write_b128 v53, v[70:73] offset:2048
    ds_write_b128 v53, v[74:77] offset:3072
    ds_write_b128 v53, v[78:81] offset:4096
    ds_write_b128 v53, v[82:85] offset:5120
    ds_write_b128 v53, v[86:89] offset:6144
    ds_write_b128 v53, v[90:93] offset:7168
    s_sub_u32 s3, s43, 8
    s_cmp_lt_u32 s3, 7
    s_cselect_b64 vcc, -1, 0
    s_waitcnt lgkmcnt(0)
    s_barrier
    ds_read_b128 v[78:81], v28 offset:0
    ds_read_b128 v[82:85], v29 offset:0
    ds_read_b128 v[86:89], v30 offset:0
    ds_read_b128 v[90:93], v31 offset:0
    s_waitcnt lgkmcnt(3)
    v_mfma_f32_32x32x16_bf16 v[62:77], a[0:3], v[78:81], 0
    ds_read_b128 v[94:97], v32 offset:0
    buffer_store_dwordx4 v[10:13], v14, s[4:7], s48 offen sc1
    s_waitcnt lgkmcnt(3)
    v_mfma_f32_32x32x16_bf16 v[62:77], a[4:7], v[82:85], v[62:77]
    ds_read_b128 v[98:101], v33 offset:0
    buffer_store_dwordx4 v[10:13], v14, s[4:7], s49 offen sc1
    s_waitcnt lgkmcnt(3)
    v_mfma_f32_32x32x16_bf16 v[62:77], a[8:11], v[86:89], v[62:77]
    ds_read_b128 v[78:81], v34 offset:0
    buffer_store_dwordx4 v[10:13], v14, s[4:7], s50 offen sc1
    s_waitcnt lgkmcnt(3)
    v_mfma_f32_32x32x16_bf16 v[62:77], a[12:15], v[90:93], v[62:77]
    ds_read_b128 v[82:85], v35 offset:0
    buffer_store_dwordx4 v[10:13], v14, s[4:7], s51 offen sc1
    s_waitcnt lgkmcnt(3)
    v_mfma_f32_32x32x16_bf16 v[62:77], a[16:19], v[94:97], v[62:77]
    ds_read_b128 v[86:89], v28 offset:8192
    buffer_store_dwordx4 v[10:13], v14, s[4:7], s52 offen sc1
    s_waitcnt lgkmcnt(3)
    v_mfma_f32_32x32x16_bf16 v[62:77], a[20:23], v[98:101], v[62:77]
    ds_read_b128 v[90:93], v29 offset:8192
    buffer_store_dwordx4 v[10:13], v14, s[4:7], s53 offen sc1
    s_waitcnt lgkmcnt(3)
    v_mfma_f32_32x32x16_bf16 v[62:77], a[24:27], v[78:81], v[62:77]
    ds_read_b128 v[94:97], v30 offset:8192
    buffer_store_dwordx4 v[10:13], v14, s[4:7], s54 offen sc1
    s_waitcnt lgkmcnt(3)
    v_mfma_f32_32x32x16_bf16 v[62:77], a[28:31], v[82:85], v[62:77]
    ds_read_b128 v[98:101], v31 offset:8192
    buffer_store_dwordx4 v[10:13], v14, s[4:7], s55 offen sc1
    s_waitcnt lgkmcnt(3)
    v_mfma_f32_32x32x16_bf16 v[62:77], a[32:35], v[86:89], v[62:77]
    ds_read_b128 v[78:81], v32 offset:8192
    buffer_store_dwordx2 v[10:11], v15, s[4:7], s56 offen sc1
    s_waitcnt lgkmcnt(3)
    v_mfma_f32_32x32x16_bf16 v[62:77], a[36:39], v[90:93], v[62:77]
    ds_read_b128 v[82:85], v33 offset:8192
    s_waitcnt lgkmcnt(3)
    v_mfma_f32_32x32x16_bf16 v[62:77], a[40:43], v[94:97], v[62:77]
    ds_read_b128 v[86:89], v34 offset:8192
    s_waitcnt lgkmcnt(3)
    v_mfma_f32_32x32x16_bf16 v[62:77], a[44:47], v[98:101], v[62:77]
    ds_read_b128 v[90:93], v35 offset:8192
    s_waitcnt lgkmcnt(3)
    v_mfma_f32_32x32x16_bf16 v[62:77], a[48:51], v[78:81], v[62:77]
    ds_read_b128 v[94:97], v28 offset:16384
    s_waitcnt lgkmcnt(3)
    v_mfma_f32_32x32x16_bf16 v[62:77], a[52:55], v[82:85], v[62:77]
    ds_read_b128 v[98:101], v29 offset:16384
    s_waitcnt lgkmcnt(3)
    v_mfma_f32_32x32x16_bf16 v[62:77], a[56:59], v[86:89], v[62:77]
    ds_read_b128 v[78:81], v30 offset:16384
    s_waitcnt lgkmcnt(3)
    v_mfma_f32_32x32x16_bf16 v[62:77], a[60:63], v[90:93], v[62:77]
    ds_read_b128 v[82:85], v31 offset:16384
    s_waitcnt lgkmcnt(3)
    v_mfma_f32_32x32x16_bf16 v[62:77], a[64:67], v[94:97], v[62:77]
    ds_read_b128 v[86:89], v32 offset:16384
    s_waitcnt lgkmcnt(3)
    v_mfma_f32_32x32x16_bf16 v[62:77], a[68:71], v[98:101], v[62:77]
    ds_read_b128 v[90:93], v33 offset:16384
    s_waitcnt lgkmcnt(3)
    v_mfma_f32_32x32x16_bf16 v[62:77], a[72:75], v[78:81], v[62:77]
    ds_read_b128 v[94:97], v34 offset:16384
    s_waitcnt lgkmcnt(3)
    v_mfma_f32_32x32x16_bf16 v[62:77], a[76:79], v[82:85], v[62:77]
    ds_read_b128 v[98:101], v35 offset:16384
    s_waitcnt lgkmcnt(3)
    v_mfma_f32_32x32x16_bf16 v[62:77], a[80:83], v[86:89], v[62:77]
    ds_read_b128 v[78:81], v28 offset:24576
    s_waitcnt lgkmcnt(3)
    v_mfma_f32_32x32x16_bf16 v[62:77], a[84:87], v[90:93], v[62:77]
    ds_read_b128 v[82:85], v29 offset:24576
    s_waitcnt lgkmcnt(3)
    v_mfma_f32_32x32x16_bf16 v[62:77], a[88:91], v[94:97], v[62:77]
    ds_read_b128 v[86:89], v30 offset:24576
    s_waitcnt lgkmcnt(3)
    v_mfma_f32_32x32x16_bf16 v[62:77], a[92:95], v[98:101], v[62:77]
    ds_read_b128 v[90:93], v31 offset:24576
    s_waitcnt lgkmcnt(3)
    v_mfma_f32_32x32x16_bf16 v[62:77], a[96:99], v[78:81], v[62:77]
    ds_read_b128 v[94:97], v32 offset:24576
    s_waitcnt lgkmcnt(3)
    v_mfma_f32_32x32x16_bf16 v[62:77], a[100:103], v[82:85], v[62:77]
    ds_read_b128 v[98:101], v33 offset:24576
    s_waitcnt lgkmcnt(3)
    v_mfma_f32_32x32x16_bf16 v[62:77], a[104:107], v[86:89], v[62:77]
    ds_read_b128 v[78:81], v34 offset:24576
    s_waitcnt lgkmcnt(3)
    v_mfma_f32_32x32x16_bf16 v[62:77], a[108:111], v[90:93], v[62:77]
    ds_read_b128 v[82:85], v35 offset:24576
    s_waitcnt lgkmcnt(3)
    v_mfma_f32_32x32x16_bf16 v[62:77], a[112:115], v[94:97], v[62:77]
    s_waitcnt lgkmcnt(2)
    v_mfma_f32_32x32x16_bf16 v[62:77], a[116:119], v[98:101], v[62:77]
    s_waitcnt lgkmcnt(1)
    v_mfma_f32_32x32x16_bf16 v[62:77], a[120:123], v[78:81], v[62:77]
    s_waitcnt lgkmcnt(0)
    v_mfma_f32_32x32x16_bf16 v[62:77], a[124:127], v[82:85], v[62:77]
    s_nop 11
    v_max3_f32 v2, v62, v63, v64
    v_max3_f32 v44, v65, v66, v67
    v_max3_f32 v2, v2, v68, v69
    v_max3_f32 v44, v44, v70, v71
    v_max3_f32 v2, v2, v72, v73
    v_max3_f32 v44, v44, v74, v75
    v_max3_f32 v2, v2, v76, v77
    v_max_f32 v2, v2, v44
    ds_write_b32 v51, v2
    s_waitcnt lgkmcnt(0)
    s_barrier
    ds_read_b128 v[104:107], v52
    ds_read_b128 v[108:111], v52 offset:512
    s_waitcnt lgkmcnt(1)
    v_max3_f32 v2, v104, v105, v106
    s_waitcnt lgkmcnt(0)
    v_max3_f32 v2, v2, v107, v108
    v_max3_f32 v2, v2, v109, v110
    v_max_f32 v2, v2, v111
    v_mul_f32 v58, s32, v2
    v_pk_fma_f32 v[62:63], v[62:63], s[32:33], v[58:59] op_sel_hi:[1,0,0] neg_lo:[0,0,1] neg_hi:[0,0,1]
    v_pk_fma_f32 v[64:65], v[64:65], s[32:33], v[58:59] op_sel_hi:[1,0,0] neg_lo:[0,0,1] neg_hi:[0,0,1]
    v_pk_fma_f32 v[66:67], v[66:67], s[32:33], v[58:59] op_sel_hi:[1,0,0] neg_lo:[0,0,1] neg_hi:[0,0,1]
    v_pk_fma_f32 v[68:69], v[68:69], s[32:33], v[58:59] op_sel_hi:[1,0,0] neg_lo:[0,0,1] neg_hi:[0,0,1]
    v_exp_f32 v62, v62
    v_exp_f32 v63, v63
    v_exp_f32 v64, v64
    v_exp_f32 v65, v65
    v_exp_f32 v66, v66
    v_exp_f32 v67, v67
    v_exp_f32 v68, v68
    v_exp_f32 v69, v69
    v_cvt_pk_bf16_f32 v78, v62, v63
    v_cvt_pk_bf16_f32 v79, v64, v65
    v_cvt_pk_bf16_f32 v80, v66, v67
    v_cvt_pk_bf16_f32 v81, v68, v69
    ds_write_b128 v49, v[78:81] offset:0
    v_pk_fma_f32 v[70:71], v[70:71], s[32:33], v[58:59] op_sel_hi:[1,0,0] neg_lo:[0,0,1] neg_hi:[0,0,1]
    v_pk_fma_f32 v[72:73], v[72:73], s[32:33], v[58:59] op_sel_hi:[1,0,0] neg_lo:[0,0,1] neg_hi:[0,0,1]
    v_pk_fma_f32 v[74:75], v[74:75], s[32:33], v[58:59] op_sel_hi:[1,0,0] neg_lo:[0,0,1] neg_hi:[0,0,1]
    v_pk_fma_f32 v[76:77], v[76:77], s[32:33], v[58:59] op_sel_hi:[1,0,0] neg_lo:[0,0,1] neg_hi:[0,0,1]
    v_exp_f32 v70, v70
    v_exp_f32 v71, v71
    v_exp_f32 v72, v72
    v_exp_f32 v73, v73
    v_exp_f32 v74, v74
    v_exp_f32 v75, v75
    v_exp_f32 v76, v76
    v_exp_f32 v77, v77
    v_cvt_pk_bf16_f32 v82, v70, v71
    v_cvt_pk_bf16_f32 v83, v72, v73
    v_cvt_pk_bf16_f32 v84, v74, v75
    v_cvt_pk_bf16_f32 v85, v76, v77
    ds_write_b128 v49, v[82:85] offset:1024
    v_pk_add_f32 v[62:63], v[62:63], v[70:71]
    v_pk_add_f32 v[64:65], v[64:65], v[72:73]
    v_pk_add_f32 v[66:67], v[66:67], v[74:75]
    v_pk_add_f32 v[68:69], v[68:69], v[76:77]
    v_pk_add_f32 v[62:63], v[62:63], v[66:67]
    v_pk_add_f32 v[64:65], v[64:65], v[68:69]
    v_pk_add_f32 v[62:63], v[62:63], v[64:65]
    v_add_f32 v2, v62, v63
    ds_write_b32 v51, v2 offset:1024
    s_waitcnt vmcnt(0)
    s_waitcnt lgkmcnt(0)
    s_barrier
    ds_read_b128 v[112:115], v50 offset:0
    ds_read_b128 v[116:119], v50 offset:2048
    ds_read_b128 v[120:123], v50 offset:4096
    ds_read_b128 v[124:127], v50 offset:6144
    ds_read_b128 v[104:107], v52 offset:1024
    ds_read_b128 v[108:111], v52 offset:1536
    ds_read_b128 v[128:131], v50 offset:256
    ds_read_b128 v[132:135], v50 offset:2304
    ds_read_b128 v[136:139], v50 offset:4352
    ds_read_b128 v[140:143], v50 offset:6400
    s_waitcnt lgkmcnt(9)
    v_mfma_f32_16x16x32_bf16 v[144:147], v[112:115], a[128:131], 0
    v_mfma_f32_16x16x32_bf16 v[148:151], v[112:115], a[144:147], 0
    s_waitcnt lgkmcnt(8)
    v_mfma_f32_16x16x32_bf16 v[144:147], v[116:119], a[132:135], v[144:147]
    v_mfma_f32_16x16x32_bf16 v[148:151], v[116:119], a[148:151], v[148:151]
    s_waitcnt lgkmcnt(7)
    v_mfma_f32_16x16x32_bf16 v[144:147], v[120:123], a[136:139], v[144:147]
    v_mfma_f32_16x16x32_bf16 v[148:151], v[120:123], a[152:155], v[148:151]
    s_waitcnt lgkmcnt(6)
    v_mfma_f32_16x16x32_bf16 v[144:147], v[124:127], a[140:143], v[144:147]
    v_mfma_f32_16x16x32_bf16 v[148:151], v[124:127], a[156:159], v[148:151]
    s_waitcnt lgkmcnt(4)
    v_pk_add_f32 v[104:105], v[104:105], v[106:107]
    v_pk_add_f32 v[108:109], v[108:109], v[110:111]
    v_mfma_f32_16x16x32_bf16 v[152:155], v[112:115], a[160:163], 0
    v_pk_add_f32 v[104:105], v[104:105], v[108:109]
    v_add_f32 v59, v104, v105
    v_mfma_f32_16x16x32_bf16 v[156:159], v[112:115], a[176:179], 0
    v_mfma_f32_16x16x32_bf16 v[152:155], v[116:119], a[164:167], v[152:155]
    s_mov_b32 exec_hi, 0
    buffer_store_dwordx4 v[58:61], v47, s[4:7], s59 offen sc1
    s_mov_b64 exec, -1
    v_mfma_f32_16x16x32_bf16 v[156:159], v[116:119], a[180:183], v[156:159]
    v_mfma_f32_16x16x32_bf16 v[152:155], v[120:123], a[168:171], v[152:155]
    v_cvt_pk_bf16_f32 v208, v144, v148
    v_cvt_pk_bf16_f32 v212, v145, v149
    v_mfma_f32_16x16x32_bf16 v[156:159], v[120:123], a[184:187], v[156:159]
    v_cvt_pk_bf16_f32 v216, v146, v150
    v_cvt_pk_bf16_f32 v220, v147, v151
    v_mfma_f32_16x16x32_bf16 v[152:155], v[124:127], a[172:175], v[152:155]
    v_min_u32 v208, -2, v208
    v_min_u32 v212, -2, v212
    v_mfma_f32_16x16x32_bf16 v[156:159], v[124:127], a[188:191], v[156:159]
    v_min_u32 v216, -2, v216
    v_min_u32 v220, -2, v220
    v_mfma_f32_16x16x32_bf16 v[160:163], v[112:115], a[192:195], 0
    v_mfma_f32_16x16x32_bf16 v[164:167], v[112:115], a[208:211], 0
    v_mfma_f32_16x16x32_bf16 v[160:163], v[116:119], a[196:199], v[160:163]
    v_mfma_f32_16x16x32_bf16 v[164:167], v[116:119], a[212:215], v[164:167]
    v_mfma_f32_16x16x32_bf16 v[160:163], v[120:123], a[200:203], v[160:163]
    s_nop 0
    v_cvt_pk_bf16_f32 v209, v152, v156
    v_cvt_pk_bf16_f32 v213, v153, v157
    v_mfma_f32_16x16x32_bf16 v[164:167], v[120:123], a[216:219], v[164:167]
    v_cvt_pk_bf16_f32 v217, v154, v158
    v_cvt_pk_bf16_f32 v221, v155, v159
    v_mfma_f32_16x16x32_bf16 v[160:163], v[124:127], a[204:207], v[160:163]
    v_mfma_f32_16x16x32_bf16 v[164:167], v[124:127], a[220:223], v[164:167]
    v_mfma_f32_16x16x32_bf16 v[168:171], v[112:115], a[224:227], 0
    v_mfma_f32_16x16x32_bf16 v[172:175], v[112:115], a[240:243], 0
    v_mfma_f32_16x16x32_bf16 v[168:171], v[116:119], a[228:231], v[168:171]
    v_mfma_f32_16x16x32_bf16 v[172:175], v[116:119], a[244:247], v[172:175]
    v_mfma_f32_16x16x32_bf16 v[168:171], v[120:123], a[232:235], v[168:171]
    s_nop 2
    v_cvt_pk_bf16_f32 v210, v160, v164
    v_cvt_pk_bf16_f32 v214, v161, v165
    v_mfma_f32_16x16x32_bf16 v[172:175], v[120:123], a[248:251], v[172:175]
    v_cvt_pk_bf16_f32 v218, v162, v166
    v_cvt_pk_bf16_f32 v222, v163, v167
    v_mfma_f32_16x16x32_bf16 v[168:171], v[124:127], a[236:239], v[168:171]
    v_mfma_f32_16x16x32_bf16 v[172:175], v[124:127], a[252:255], v[172:175]
    s_waitcnt lgkmcnt(3)
    v_mfma_f32_16x16x32_bf16 v[176:179], v[128:131], a[128:131], 0
    v_mfma_f32_16x16x32_bf16 v[180:183], v[128:131], a[144:147], 0
    s_waitcnt lgkmcnt(2)
    v_mfma_f32_16x16x32_bf16 v[176:179], v[132:135], a[132:135], v[176:179]
    v_mfma_f32_16x16x32_bf16 v[180:183], v[132:135], a[148:151], v[180:183]
    s_waitcnt lgkmcnt(1)
    v_mfma_f32_16x16x32_bf16 v[176:179], v[136:139], a[136:139], v[176:179]
    v_cvt_pk_bf16_f32 v211, v168, v172
    v_cvt_pk_bf16_f32 v215, v169, v173
    v_mfma_f32_16x16x32_bf16 v[180:183], v[136:139], a[152:155], v[180:183]
    v_cvt_pk_bf16_f32 v219, v170, v174
    v_cvt_pk_bf16_f32 v223, v171, v175
    s_waitcnt lgkmcnt(0)
    v_mfma_f32_16x16x32_bf16 v[176:179], v[140:143], a[140:143], v[176:179]
    buffer_store_dwordx4 v[208:211], v14, s[4:7], s48 offen sc1
    v_mfma_f32_16x16x32_bf16 v[180:183], v[140:143], a[156:159], v[180:183]
    buffer_store_dwordx4 v[212:215], v14, s[4:7], s49 offen sc1
    v_mfma_f32_16x16x32_bf16 v[184:187], v[128:131], a[160:163], 0
    buffer_store_dwordx4 v[216:219], v14, s[4:7], s50 offen sc1
    v_mfma_f32_16x16x32_bf16 v[188:191], v[128:131], a[176:179], 0
    buffer_store_dwordx4 v[220:223], v14, s[4:7], s51 offen sc1
    v_mfma_f32_16x16x32_bf16 v[184:187], v[132:135], a[164:167], v[184:187]
    v_mfma_f32_16x16x32_bf16 v[188:191], v[132:135], a[180:183], v[188:191]
    v_mfma_f32_16x16x32_bf16 v[184:187], v[136:139], a[168:171], v[184:187]
    v_cvt_pk_bf16_f32 v224, v176, v180
    v_cvt_pk_bf16_f32 v228, v177, v181
    v_mfma_f32_16x16x32_bf16 v[188:191], v[136:139], a[184:187], v[188:191]
    v_cvt_pk_bf16_f32 v232, v178, v182
    v_cvt_pk_bf16_f32 v236, v179, v183
    v_mfma_f32_16x16x32_bf16 v[184:187], v[140:143], a[172:175], v[184:187]
    v_min_u32 v224, -2, v224
    v_min_u32 v228, -2, v228
    v_mfma_f32_16x16x32_bf16 v[188:191], v[140:143], a[188:191], v[188:191]
    v_min_u32 v232, -2, v232
    v_min_u32 v236, -2, v236
    v_mfma_f32_16x16x32_bf16 v[192:195], v[128:131], a[192:195], 0
    v_mfma_f32_16x16x32_bf16 v[196:199], v[128:131], a[208:211], 0
    v_mfma_f32_16x16x32_bf16 v[192:195], v[132:135], a[196:199], v[192:195]
    v_mfma_f32_16x16x32_bf16 v[196:199], v[132:135], a[212:215], v[196:199]
    v_mfma_f32_16x16x32_bf16 v[192:195], v[136:139], a[200:203], v[192:195]
    s_nop 0
    v_cvt_pk_bf16_f32 v225, v184, v188
    v_cvt_pk_bf16_f32 v229, v185, v189
    v_mfma_f32_16x16x32_bf16 v[196:199], v[136:139], a[216:219], v[196:199]
    v_cvt_pk_bf16_f32 v233, v186, v190
    v_cvt_pk_bf16_f32 v237, v187, v191
    v_mfma_f32_16x16x32_bf16 v[192:195], v[140:143], a[204:207], v[192:195]
    v_mfma_f32_16x16x32_bf16 v[196:199], v[140:143], a[220:223], v[196:199]
    v_mfma_f32_16x16x32_bf16 v[200:203], v[128:131], a[224:227], 0
    v_mfma_f32_16x16x32_bf16 v[204:207], v[128:131], a[240:243], 0
    v_mfma_f32_16x16x32_bf16 v[200:203], v[132:135], a[228:231], v[200:203]
    v_mfma_f32_16x16x32_bf16 v[204:207], v[132:135], a[244:247], v[204:207]
    v_mfma_f32_16x16x32_bf16 v[200:203], v[136:139], a[232:235], v[200:203]
    s_nop 2
    v_cvt_pk_bf16_f32 v226, v192, v196
    v_cvt_pk_bf16_f32 v230, v193, v197
    v_mfma_f32_16x16x32_bf16 v[204:207], v[136:139], a[248:251], v[204:207]
    v_cvt_pk_bf16_f32 v234, v194, v198
    v_cvt_pk_bf16_f32 v238, v195, v199
    v_mfma_f32_16x16x32_bf16 v[200:203], v[140:143], a[236:239], v[200:203]
    v_mfma_f32_16x16x32_bf16 v[204:207], v[140:143], a[252:255], v[204:207]
    s_nop 7
    v_cvt_pk_bf16_f32 v227, v200, v204
    v_cvt_pk_bf16_f32 v231, v201, v205
    v_cvt_pk_bf16_f32 v235, v202, v206
    v_cvt_pk_bf16_f32 v239, v203, v207
    buffer_store_dwordx4 v[224:227], v14, s[4:7], s52 offen sc1
    buffer_store_dwordx4 v[228:231], v14, s[4:7], s53 offen sc1
    buffer_store_dwordx4 v[232:235], v14, s[4:7], s54 offen sc1
    buffer_store_dwordx4 v[236:239], v14, s[4:7], s55 offen sc1
    s_cbranch_vccnz La_tail
    s_endpgm
La_tail:
    s_mov_b32 s47, s13
    s_add_u32 m0, s46, 32768
    s_nop 0
    buffer_load_dwordx4 v55, s[28:31], s47 offen nt lds
    s_add_u32 s47, s47, s15
    s_add_u32 m0, s46, 33792
    s_nop 0
    buffer_load_dwordx4 v55, s[28:31], s47 offen nt lds
    s_add_u32 s47, s47, s15
    s_add_u32 m0, s46, 34816
    s_nop 0
    buffer_load_dwordx4 v55, s[28:31], s47 offen nt lds
    s_add_u32 s47, s47, s15
    s_add_u32 m0, s46, 35840
    s_nop 0
    buffer_load_dwordx4 v55, s[28:31], s47 offen nt lds
    s_add_u32 s47, s47, s15
    s_add_u32 m0, s46, 36864
    s_nop 0
    buffer_load_dwordx4 v55, s[28:31], s47 offen nt lds
    s_add_u32 s47, s47, s15
    s_add_u32 m0, s46, 37888
    s_nop 0
    buffer_load_dwordx4 v55, s[28:31], s47 offen nt lds
    s_add_u32 s47, s47, s15
    s_add_u32 m0, s46, 38912
    s_nop 0
    buffer_load_dwordx4 v55, s[28:31], s47 offen nt lds
    s_add_u32 s47, s47, s15
    s_add_u32 m0, s46, 39936
    s_nop 0
    buffer_load_dwordx4 v55, s[28:31], s47 offen nt lds
    s_mov_b32 s47, s12
    s_add_u32 m0, s46, 0
    s_nop 0
    buffer_load_dwordx4 v54, s[24:27], s47 offen nt lds
    s_add_u32 s47, s47, s14
    s_add_u32 m0, s46, 1024
    s_nop 0
    buffer_load_dwordx4 v54, s[24:27], s47 offen nt lds
    s_add_u32 s47, s47, s14
    s_add_u32 m0, s46, 2048
    s_nop 0
    buffer_load_dwordx4 v54, s[24:27], s47 offen nt lds
    s_add_u32 s47, s47, s14
    s_add_u32 m0, s46, 3072
    s_nop 0
    buffer_load_dwordx4 v54, s[24:27], s47 offen nt lds
    s_add_u32 s47, s47, s14
    s_add_u32 m0, s46, 4096
    s_nop 0
    buffer_load_dwordx4 v54, s[24:27], s47 offen nt lds
    s_add_u32 s47, s47, s14
    s_add_u32 m0, s46, 5120
    s_nop 0
    buffer_load_dwordx4 v54, s[24:27], s47 offen nt lds
    s_add_u32 s47, s47, s14
    s_add_u32 m0, s46, 6144
    s_nop 0
    buffer_load_dwordx4 v54, s[24:27], s47 offen nt lds
    s_add_u32 s47, s47, s14
    s_add_u32 m0, s46, 7168
    s_nop 0
    buffer_load_dwordx4 v54, s[24:27], s47 offen nt lds
    v_bfe_u32 v160, v0, 1, 3
    v_lshlrev_b32 v170, 4, v17
    s_mov_b32 s3, 0x3f80
    v_lshlrev_b32 v170, v170, s3
    v_cmp_eq_u32 vcc, 0, v160
    s_nop 1
    v_cndmask_b32 v162, 0, v170, vcc
    v_cmp_eq_u32 vcc, 1, v160
    s_nop 1
    v_cndmask_b32 v163, 0, v170, vcc
    v_cmp_eq_u32 vcc, 2, v160
    s_nop 1
    v_cndmask_b32 v164, 0, v170, vcc
    v_cmp_eq_u32 vcc, 3, v160
    s_nop 1
    v_cndmask_b32 v165, 0, v170, vcc
    v_cmp_eq_u32 vcc, 4, v160
    s_nop 1
    v_cndmask_b32 v166, 0, v170, vcc
    v_cmp_eq_u32 vcc, 5, v160
    s_nop 1
    v_cndmask_b32 v167, 0, v170, vcc
    v_cmp_eq_u32 vcc, 6, v160
    s_nop 1
    v_cndmask_b32 v168, 0, v170, vcc
    v_cmp_eq_u32 vcc, 7, v160
    s_nop 1
    v_cndmask_b32 v169, 0, v170, vcc
    s_mov_b32 s3, 98304
    v_lshl_add_u32 v171, v3, 4, s3
    s_mov_b32 s3, 1056
    v_mad_u32_u24 v171, v17, s3, v171
    v_lshlrev_b32 v172, 8, v45
    v_lshl_add_u32 v172, v42, 7, v172
    v_lshl_add_u32 v172, v4, 3, v172
    s_mov_b32 s3, 98304
    v_lshl_add_u32 v173, v172, 0, s3
    s_mov_b32 s3, 1056
    v_mad_u32_u24 v173, v46, s3, v173
    v_lshlrev_b32 v172, 0, v172
    v_lshl_add_u32 v172, v46, 10, v172
    v_lshlrev_b32 v174, 9, v45
    v_lshl_add_u32 v174, v42, 8, v174
    v_lshl_add_u32 v174, v41, 7, v174
    v_lshl_add_u32 v174, v46, 6, v174
    v_lshl_add_u32 v174, v40, 3, v174
    v_lshlrev_b32 v175, 11, v3
    v_lshl_add_u32 v175, v45, 9, v175
    v_lshl_add_u32 v175, v4, 4, v175
    v_bfe_u32 v176, v0, 6, 1
    v_xor_b32 v2, v46, v176
    v_lshlrev_b32 v177, 9, v3
    v_lshl_add_u32 v177, v18, 6, v177
    v_lshl_add_u32 v177, v2, 5, v177
    v_lshl_add_u32 v177, v56, 3, v177
    s_mov_b32 s3, 32768
    v_lshl_add_u32 v178, v45, 13, s3
    v_lshl_add_u32 v178, v3, 11, v178
    v_lshl_add_u32 v178, v56, 3, v178
    s_mov_b32 s3, 320
    v_mad_u32_u24 v178, v18, s3, v178
    s_mov_b32 s3, 102400
    v_lshl_add_u32 v179, v46, 5, s3
    v_lshl_add_u32 v179, v42, 4, v179
    v_lshl_add_u32 v179, v45, 2, v179
    s_mov_b32 s3, 102400
    v_lshl_add_u32 v180, v46, 5, s3
    s_mov_b32 s3, 103424
    v_lshl_add_u32 v181, v3, 3, s3
    v_lshl_add_u32 v181, v45, 5, v181
    s_mov_b32 s3, 96
    v_mad_u32_u24 v181, v17, s3, v181
    s_mov_b32 s3, 103424
    v_lshl_add_u32 v182, v3, 4, s3
    s_mov_b32 s3, 96
    v_mad_u32_u24 v182, v17, s3, v182
    s_mov_b32 s48, 40960
    s_mov_b32 s49, 45056
    s_mov_b32 s50, 49152
    s_mov_b32 s51, 57344
    v_accvgpr_write_b32 a32, 0
    v_accvgpr_write_b32 a33, 0
    v_accvgpr_write_b32 a34, 0
    v_accvgpr_write_b32 a35, 0
    v_accvgpr_write_b32 a36, 0
    v_accvgpr_write_b32 a37, 0
    v_accvgpr_write_b32 a38, 0
    v_accvgpr_write_b32 a39, 0
    v_accvgpr_write_b32 a40, 0
    v_accvgpr_write_b32 a41, 0
    v_accvgpr_write_b32 a42, 0
    v_accvgpr_write_b32 a43, 0
    v_accvgpr_write_b32 a44, 0
    v_accvgpr_write_b32 a45, 0
    v_accvgpr_write_b32 a46, 0
    v_accvgpr_write_b32 a47, 0
    v_accvgpr_write_b32 a48, 0
    v_accvgpr_write_b32 a49, 0
    v_accvgpr_write_b32 a50, 0
    v_accvgpr_write_b32 a51, 0
    v_accvgpr_write_b32 a52, 0
    v_accvgpr_write_b32 a53, 0
    v_accvgpr_write_b32 a54, 0
    v_accvgpr_write_b32 a55, 0
    v_accvgpr_write_b32 a56, 0
    v_accvgpr_write_b32 a57, 0
    v_accvgpr_write_b32 a58, 0
    v_accvgpr_write_b32 a59, 0
    v_accvgpr_write_b32 a60, 0
    v_accvgpr_write_b32 a61, 0
    v_accvgpr_write_b32 a62, 0
    v_accvgpr_write_b32 a63, 0
    buffer_load_dwordx2 v[84:85], v172, s[8:11], 0 offen
    s_mov_b32 s44, 39999
Lpoll_30:
    buffer_load_dwordx2 v[78:79], v174, s[4:7], s48 offen sc1
    buffer_load_dwordx2 v[80:81], v174, s[4:7], s48 offen offset:2048 sc1
    buffer_load_dwordx2 v[82:83], v174, s[4:7], s49 offen sc1
Lchk_32:
    s_waitcnt vmcnt(0)
    v_max3_u32 v2, v78, v80, v82
    v_cmp_eq_u32 vcc, -1, v2
    s_cbranch_vccz Ldone_31
    s_sub_u32 s44, s44, 1
    s_cbranch_scc0 Lpoll_30
Ldone_31:
    s_barrier
    v_xor_b32 v104, 0, v178
    v_xor_b32 v105, 32, v178
    v_xor_b32 v106, 64, v178
    v_xor_b32 v107, 96, v178
    v_xor_b32 v108, 128, v178
    v_xor_b32 v109, 160, v178
    v_xor_b32 v110, 192, v178
    v_xor_b32 v111, 224, v178
    ds_read_b64_tr_b16 a[64:65], v177 offset:0
    ds_read_b64_tr_b16 a[66:67], v177 offset:256
    ds_read_b64_tr_b16 a[68:69], v177 offset:2048
    ds_read_b64_tr_b16 a[70:71], v177 offset:2304
    ds_read_b64_tr_b16 a[72:73], v177 offset:4096
    ds_read_b64_tr_b16 a[74:75], v177 offset:4352
    ds_read_b64_tr_b16 a[76:77], v177 offset:6144
    ds_read_b64_tr_b16 a[78:79], v177 offset:6400
    ds_read_b64_tr_b16 a[80:81], v177 offset:8192
    ds_read_b64_tr_b16 a[82:83], v177 offset:8448
    ds_read_b64_tr_b16 a[84:85], v177 offset:10240
    ds_read_b64_tr_b16 a[86:87], v177 offset:10496
    ds_read_b64_tr_b16 a[88:89], v177 offset:12288
    ds_read_b64_tr_b16 a[90:91], v177 offset:12544
    ds_read_b64_tr_b16 a[92:93], v177 offset:14336
    s_waitcnt lgkmcnt(7)
    ds_read_b64_tr_b16 a[94:95], v177 offset:14592
    ds_read_b64_tr_b16 a[96:97], v177 offset:16384
    ds_read_b64_tr_b16 a[98:99], v177 offset:16640
    ds_read_b64_tr_b16 a[100:101], v177 offset:18432
    ds_read_b64_tr_b16 a[102:103], v177 offset:18688
    ds_read_b64_tr_b16 a[104:105], v177 offset:20480
    ds_read_b64_tr_b16 a[106:107], v177 offset:20736
    ds_read_b64_tr_b16 a[108:109], v177 offset:22528
    s_waitcnt lgkmcnt(7)
    ds_read_b64_tr_b16 a[110:111], v177 offset:22784
    ds_read_b64_tr_b16 a[112:113], v177 offset:24576
    ds_read_b64_tr_b16 a[114:115], v177 offset:24832
    ds_read_b64_tr_b16 a[116:117], v177 offset:26624
    ds_read_b64_tr_b16 a[118:119], v177 offset:26880
    ds_read_b64_tr_b16 a[120:121], v177 offset:28672
    ds_read_b64_tr_b16 a[122:123], v177 offset:28928
    ds_read_b64_tr_b16 a[124:125], v177 offset:30720
    s_waitcnt lgkmcnt(7)
    ds_read_b64_tr_b16 a[126:127], v177 offset:30976
    ds_read_b64_tr_b16 a[0:1], v104 offset:0
    ds_read_b64_tr_b16 a[2:3], v104 offset:1024
    ds_read_b64_tr_b16 a[4:5], v105 offset:0
    ds_read_b64_tr_b16 a[6:7], v105 offset:1024
    ds_read_b64_tr_b16 a[8:9], v106 offset:0
    ds_read_b64_tr_b16 a[10:11], v106 offset:1024
    ds_read_b64_tr_b16 a[12:13], v107 offset:0
    s_waitcnt lgkmcnt(7)
    ds_read_b64_tr_b16 a[14:15], v107 offset:1024
    ds_read_b64_tr_b16 a[16:17], v108 offset:0
    ds_read_b64_tr_b16 a[18:19], v108 offset:1024
    ds_read_b64_tr_b16 a[20:21], v109 offset:0
    ds_read_b64_tr_b16 a[22:23], v109 offset:1024
    ds_read_b64_tr_b16 a[24:25], v110 offset:0
    ds_read_b64_tr_b16 a[26:27], v110 offset:1024
    ds_read_b64_tr_b16 a[28:29], v111 offset:0
    s_waitcnt lgkmcnt(7)
    ds_read_b64_tr_b16 a[30:31], v111 offset:1024
    v_lshlrev_b32 v20, 16, v78
    v_and_b32 v21, 0xffff0000, v78
    v_lshlrev_b32 v22, 16, v79
    v_and_b32 v23, 0xffff0000, v79
    v_lshlrev_b32 v24, 16, v80
    v_and_b32 v25, 0xffff0000, v80
    v_lshlrev_b32 v26, 16, v81
    v_and_b32 v27, 0xffff0000, v81
    v_lshlrev_b32 v28, 16, v82
    v_and_b32 v29, 0xffff0000, v82
    v_lshlrev_b32 v30, 16, v83
    v_and_b32 v31, 0xffff0000, v83
    v_lshlrev_b32 v32, 16, v84
    v_and_b32 v33, 0xffff0000, v84
    v_lshlrev_b32 v34, 16, v85
    v_and_b32 v35, 0xffff0000, v85
    v_add_f32 v28, 1.0, v28
    v_add_f32 v29, 1.0, v29
    v_add_f32 v30, 1.0, v30
    v_add_f32 v31, 1.0, v31
    s_waitcnt lgkmcnt(0)
    s_mov_b32 s44, 39999
Lpoll_33:
    buffer_load_dwordx4 v[78:81], v175, s[4:7], s50 offen offset:0 sc1
    buffer_load_dwordx4 v[82:85], v175, s[4:7], s50 offen offset:256 sc1
    buffer_load_dwordx4 v[86:89], v175, s[4:7], s51 offen offset:0 sc1
    buffer_load_dwordx4 v[90:93], v175, s[4:7], s51 offen offset:256 sc1
Lchk_35:
    s_waitcnt vmcnt(0)
    v_max_u32 v2, v78, v82
    v_max3_u32 v2, v2, v86, v90
    v_cmp_eq_u32 vcc, -1, v2
    s_cbranch_vccz Ldone_34
    s_sub_u32 s44, s44, 1
    s_cbranch_scc0 Lpoll_33
Ldone_34:
    v_mfma_f32_16x16x32_bf16 v[62:65], v[162:165], v[78:81], 0
    v_mfma_f32_16x16x32_bf16 v[62:65], v[166:169], v[82:85], v[62:65]
    v_mfma_f32_16x16x32_bf16 v[62:65], v[162:165], v[86:89], v[62:65]
    v_mfma_f32_16x16x32_bf16 v[62:65], v[166:169], v[90:93], v[62:65]
    s_nop 7
    v_pk_fma_f32 v[32:33], v[20:21], v[62:63], v[32:33]
    v_pk_fma_f32 v[34:35], v[22:23], v[64:65], v[34:35]
    v_pk_mul_f32 v[104:105], v[32:33], v[32:33]
    v_pk_add_f32 v[106:107], v[32:33], v[34:35]
    v_pk_fma_f32 v[104:105], v[34:35], v[34:35], v[104:105]
    v_add_f32 v106, v106, v107
    v_add_f32 v104, v104, v105
    s_nop 1
    v_permlane32_swap_b32 v106, v104
    v_add_f32 v104, v106, v104
    s_nop 1
    v_add_f32_dpp v104, v104, v104 quad_perm:[1,0,3,2] row_mask:0xf bank_mask:0xf
    s_nop 1
    v_add_f32_dpp v104, v104, v104 quad_perm:[2,3,0,1] row_mask:0xf bank_mask:0xf
    s_nop 1
    v_add_f32_dpp v104, v104, v104 row_half_mirror row_mask:0xf bank_mask:0xf
    s_nop 1
    v_add_f32_dpp v104, v104, v104 row_mirror row_mask:0xf bank_mask:0xf
    ds_write_b32 v179, v104
    s_waitcnt lgkmcnt(0)
    s_barrier
    ds_read_b128 v[104:107], v180
    ds_read_b128 v[108:111], v180 offset:16
    s_waitcnt lgkmcnt(1)
    v_pk_add_f32 v[104:105], v[104:105], v[106:107]
    s_waitcnt lgkmcnt(0)
    v_pk_add_f32 v[108:109], v[108:109], v[110:111]
    v_add_f32 v104, v104, v105
    v_add_f32 v108, v108, v109
    v_mul_f32 v104, 0x3b000000, v104
    v_mul_f32 v108, 0x3b000000, v108
    v_fma_f32 v108, -v104, v104, v108
    v_max_f32 v108, 0, v108
    v_add_f32 v108, 0x3727c5ac, v108
    v_rsq_f32 v108, v108
    v_pk_add_f32 v[32:33], v[32:33], v[104:105] op_sel_hi:[1,0] neg_lo:[0,1] neg_hi:[0,1]
    v_pk_add_f32 v[34:35], v[34:35], v[104:105] op_sel_hi:[1,0] neg_lo:[0,1] neg_hi:[0,1]
    v_pk_mul_f32 v[32:33], v[32:33], v[28:29]
    v_pk_mul_f32 v[34:35], v[34:35], v[30:31]
    v_pk_fma_f32 v[32:33], v[32:33], v[108:109], v[24:25] op_sel_hi:[1,0,1]
    v_pk_fma_f32 v[34:35], v[34:35], v[108:109], v[26:27] op_sel_hi:[1,0,1]
    v_cvt_pk_bf16_f32 v104, v32, v33
    v_cvt_pk_bf16_f32 v105, v34, v35
    ds_write_b64 v173, v[104:105]
    s_waitcnt lgkmcnt(0)
    s_barrier
    s_cmp_ge_u32 s41, 2
    s_cbranch_scc1 Lf_now1
    ds_read_b128 v[112:115], v171 offset:0
    ds_read_b128 v[116:119], v171 offset:64
    ds_read_b128 v[120:123], v171 offset:128
    ds_read_b128 v[124:127], v171 offset:192
    ds_read_b128 v[128:131], v171 offset:256
    ds_read_b128 v[132:135], v171 offset:320
    ds_read_b128 v[136:139], v171 offset:384
    ds_read_b128 v[140:143], v171 offset:448
    ds_read_b128 v[144:147], v171 offset:512
    ds_read_b128 v[148:151], v171 offset:576
    ds_read_b128 v[152:155], v171 offset:640
    ds_read_b128 v[156:159], v171 offset:704
    s_waitcnt lgkmcnt(11)
    v_mfma_f32_16x16x32_bf16 v[66:69], a[64:67], v[112:115], 0
    s_waitcnt lgkmcnt(10)
    v_mfma_f32_16x16x32_bf16 v[66:69], a[68:71], v[116:119], v[66:69]
    ds_read_b128 v[112:115], v171 offset:768
    s_waitcnt lgkmcnt(10)
    v_mfma_f32_16x16x32_bf16 v[66:69], a[72:75], v[120:123], v[66:69]
    ds_read_b128 v[116:119], v171 offset:832
    s_waitcnt lgkmcnt(10)
    v_mfma_f32_16x16x32_bf16 v[66:69], a[76:79], v[124:127], v[66:69]
    ds_read_b128 v[120:123], v171 offset:896
    s_waitcnt lgkmcnt(10)
    v_mfma_f32_16x16x32_bf16 v[66:69], a[80:83], v[128:131], v[66:69]
    ds_read_b128 v[124:127], v171 offset:960
    s_waitcnt lgkmcnt(10)
    v_mfma_f32_16x16x32_bf16 v[66:69], a[84:87], v[132:135], v[66:69]
    s_waitcnt lgkmcnt(9)
    v_mfma_f32_16x16x32_bf16 v[66:69], a[88:91], v[136:139], v[66:69]
    s_waitcnt lgkmcnt(8)
    v_mfma_f32_16x16x32_bf16 v[66:69], a[92:95], v[140:143], v[66:69]
    s_waitcnt lgkmcnt(7)
    v_mfma_f32_16x16x32_bf16 v[66:69], a[96:99], v[144:147], v[66:69]
    s_waitcnt lgkmcnt(6)
    v_mfma_f32_16x16x32_bf16 v[66:69], a[100:103], v[148:151], v[66:69]
    s_waitcnt lgkmcnt(5)
    v_mfma_f32_16x16x32_bf16 v[66:69], a[104:107], v[152:155], v[66:69]
    s_waitcnt lgkmcnt(4)
    v_mfma_f32_16x16x32_bf16 v[66:69], a[108:111], v[156:159], v[66:69]
    s_waitcnt lgkmcnt(3)
    v_mfma_f32_16x16x32_bf16 v[66:69], a[112:115], v[112:115], v[66:69]
    s_waitcnt lgkmcnt(2)
    v_mfma_f32_16x16x32_bf16 v[66:69], a[116:119], v[116:119], v[66:69]
    s_waitcnt lgkmcnt(1)
    v_mfma_f32_16x16x32_bf16 v[66:69], a[120:123], v[120:123], v[66:69]
    s_waitcnt lgkmcnt(0)
    v_mfma_f32_16x16x32_bf16 v[66:69], a[124:127], v[124:127], v[66:69]
    s_nop 7
    v_max_f32 v66, 0, v66
    v_max_f32 v67, 0, v67
    v_max_f32 v68, 0, v68
    v_max_f32 v69, 0, v69
    v_cvt_pk_bf16_f32 v104, v66, v67
    v_cvt_pk_bf16_f32 v105, v68, v69
    ds_write_b64 v181, v[104:105]
    s_waitcnt lgkmcnt(0)
Lf_now1:
    s_mov_b32 exec_lo, 0x30003
    s_mov_b32 exec_hi, 0x30003
    s_barrier
    ds_read_b128 a[32:35], v182
    s_lshl_b64 exec, exec, 2
    ds_read_b128 a[36:39], v182
    s_lshl_b64 exec, exec, 2
    ds_read_b128 a[40:43], v182
    s_lshl_b64 exec, exec, 2
    ds_read_b128 a[44:47], v182
    s_lshl_b64 exec, exec, 2
    ds_read_b128 a[48:51], v182
    s_lshl_b64 exec, exec, 2
    ds_read_b128 a[52:55], v182
    s_lshl_b64 exec, exec, 2
    ds_read_b128 a[56:59], v182
    s_lshl_b64 exec, exec, 2
    ds_read_b128 a[60:63], v182
    s_mov_b64 exec, -1
    s_waitcnt lgkmcnt(7)
    v_mfma_f32_16x16x32_bf16 v[62:65], a[0:3], a[32:35], 0
    s_waitcnt lgkmcnt(6)
    v_mfma_f32_16x16x32_bf16 v[62:65], a[4:7], a[36:39], v[62:65]
    s_waitcnt lgkmcnt(5)
    v_mfma_f32_16x16x32_bf16 v[62:65], a[8:11], a[40:43], v[62:65]
    s_waitcnt lgkmcnt(4)
    v_mfma_f32_16x16x32_bf16 v[62:65], a[12:15], a[44:47], v[62:65]
    s_waitcnt lgkmcnt(3)
    v_mfma_f32_16x16x32_bf16 v[62:65], a[16:19], a[48:51], v[62:65]
    s_waitcnt lgkmcnt(2)
    v_mfma_f32_16x16x32_bf16 v[62:65], a[20:23], a[52:55], v[62:65]
    s_waitcnt lgkmcnt(1)
    v_mfma_f32_16x16x32_bf16 v[62:65], a[24:27], a[56:59], v[62:65]
    s_waitcnt lgkmcnt(0)
    v_mfma_f32_16x16x32_bf16 v[62:65], a[28:31], a[60:63], v[62:65]
    s_nop 7
    v_cvt_pk_bf16_f32 v104, v62, v63
    v_cvt_pk_bf16_f32 v105, v64, v65
    v_min_u32 v104, -2, v104
    buffer_store_dwordx2 v[104:105], v15, s[4:7], s56 offen sc1
    s_endpgm
.section .rodata,"a"
.p2align 6
.amdhsa_kernel adaLN_cond__compressed_kv_cla__dense_activation_relu__decode_kernel
  .amdhsa_next_free_vgpr 512
  .amdhsa_next_free_sgpr 102
  .amdhsa_accum_offset 256
  .amdhsa_group_segment_fixed_size 0
  .amdhsa_kernarg_size 112
  .amdhsa_user_sgpr_count 2
  .amdhsa_user_sgpr_kernarg_segment_ptr 1
  .amdhsa_system_sgpr_workgroup_id_x 1
.end_amdhsa_kernel
```
